```python
import torch

def _softmax(x, axis=-1):
    return torch.softmax(x, dim=axis)
def _gelu(x):
    return torch.nn.functional.gelu(x, approximate="tanh")
def _silu(x):
    return torch.nn.functional.silu(x)
def _sigmoid(x):
    return torch.sigmoid(x)
def _layernorm(x, axis=-1, eps=1e-5):
    m = x.mean(dim=axis, keepdim=True)
    v = x.var(dim=axis, keepdim=True, unbiased=False)
    return (x - m) / torch.sqrt(v + eps)
def _scatter_add(tgt, idx, src, axis=0):
    return tgt.clone().index_add_(axis, idx, src)
def _segment_sum(src, seg, n):
    out = torch.zeros((n,) + src.shape[1:], dtype=src.dtype)
    return out.index_add_(0, seg, src)
def _pad(x, pw):
    flat = tuple(v for pair in reversed(pw) for v in pair)
    return torch.nn.functional.pad(x, flat)

kernel_name = 'parallel_sum__sliding_local_dilated__mixer_channel_mlp__prompt'

def setup_inputs():

    _w = (lambda a: (lambda t: t.to(torch.bfloat16) if t.is_floating_point() else t)(torch.as_tensor(a)))
    def _A_setup():
        B, S, D = 1, 2048, 512
        return {
            "x": _w((lambda *s: torch.randn(*s, dtype=torch.bfloat16) * 0.05)(B, S, D)),
            "wqkv": _w((lambda *s: torch.randn(*s, dtype=torch.bfloat16) * 0.05)(D, 3 * D)),
            "wo": _w((lambda *s: torch.randn(*s, dtype=torch.bfloat16) * 0.05)(D, D)),
        }
    _A_in = _A_setup()

    def _B_setup():
        B, S, D, F = 1, 2048, 512, 1376
        return {
            "x": _w((lambda *s: torch.randn(*s, dtype=torch.bfloat16) * 0.05)(B, S, D)),
            "w1": _w((lambda *s: torch.randn(*s, dtype=torch.bfloat16) * 3.2)(D, F) * (D ** -0.5)),
            "b1": _w((lambda *s: torch.randn(*s, dtype=torch.bfloat16) * 1.6)(F)),
            "w2": _w((lambda *s: torch.randn(*s, dtype=torch.bfloat16) * 0.2)(F, D) * (F ** -0.5)),
            "b2": _w((lambda *s: torch.randn(*s, dtype=torch.bfloat16) * 0.2)(D)),
        }
    _B_in = _B_setup()

    return {
        "A_x": _A_in["x"],
        "A_wqkv": _A_in["wqkv"],
        "A_wo": _A_in["wo"],
        "B_x": _B_in["x"],
        "B_w1": _B_in["w1"],
        "B_b1": _B_in["b1"],
        "B_w2": _B_in["w2"],
        "B_b2": _B_in["b2"],
    }

def reference(A_x, A_wqkv, A_wo, B_x, B_w1, B_b1, B_w2, B_b2):
    def _A_ref(x, wqkv, wo):
        B, S, D = x.shape
        H = 32; Dh = D // H
        W, dil = 8, 2
        qkv = (lambda x, *d: x.permute(*d))((x @ wqkv).reshape(B, S, 3, H, Dh), 2, 0, 3, 1, 4)
        q, k, v = qkv[0], qkv[1], qkv[2]
        scale = Dh ** -0.5
        pos = torch.arange(S)
        off = torch.arange(W) * dil
        idx = pos[:, None] - off[None, :]
        mask = idx >= 0
        idx_c = torch.where(mask, idx, 0).reshape(-1)
        kg = k[:, :, idx_c, :].reshape(B, H, S, W, Dh)
        vg = v[:, :, idx_c, :].reshape(B, H, S, W, Dh)
        logits = torch.einsum("bhsd,bhswd->bhsw", q, kg) * scale
        logits = torch.where(mask[None, None, :, :], logits, -1e9)
        attn = _softmax(logits, axis=-1)
        o = torch.einsum("bhsw,bhswd->bhsd", attn, vg)
        return (lambda x, *d: x.permute(*d))(o, 0, 2, 1, 3).reshape(B, S, D) @ wo

    def _B_ref(x, w1, b1, w2, b2):
        y = _layernorm(x, axis=-1)
        h = _gelu(torch.einsum("bsd,df->bsf", y, w1) + b1)
        return torch.einsum("bsf,fd->bsd", h, w2) + b2

    x = A_x
    xn = _layernorm(x, axis=-1)
    return x + _A_ref(xn, A_wqkv, A_wo) + _B_ref(xn, B_w1, B_b1, B_w2, B_b2)
```

```asm
; @launch grid=(256,1,1) block=(512,1,1) lds=163840
.amdgcn_target "amdgcn-amd-amdhsa--gfx950"
.text
.globl parallel_sum__sliding_local_dilated__mixer_channel_mlp__prompt_kernel
.p2align 8
.type parallel_sum__sliding_local_dilated__mixer_channel_mlp__prompt_kernel,@function
parallel_sum__sliding_local_dilated__mixer_channel_mlp__prompt_kernel:
    s_cmp_ge_u32 s2, 256
    s_cbranch_scc1 L_exit
    s_load_dwordx16 s[16:31], s[0:1], 0
    s_load_dwordx4 s[32:35], s[0:1], 64
    s_load_dwordx2 s[36:37], s[0:1], 80
    s_getpc_b64 s[96:97]
L_pc0:
    v_lshlrev_b32 v2, 7, v0
    v_min_u32 v2, L_code_end-L_pc0-4, v2
    global_load_dword v23, v2, s[96:97]
    v_lshrrev_b32 v1, 6, v0
    v_and_b32 v0, 63, v0
    v_readfirstlane_b32 s8, v1
    s_and_b32 s87, s2, 7
    s_lshr_b32 s88, s2, 3
    s_lshr_b32 s13, s87, 1
    s_lshr_b32 s14, s88, 3
    s_and_b32 s9, s88, 7
    s_and_b32 s15, s87, 1
    s_lshl_b32 s15, s15, 3
    s_add_u32 s9, s9, s15
    s_cmp_eq_u32 s13, 3
    s_cselect_b32 s15, 1, 0
    s_add_u32 s15, s14, s15
    s_lshl_b32 s10, s13, 1
    s_add_u32 s10, s10, s15
    s_sub_u32 s10, s10, 1
    s_add_u32 s38, s13, 3
    s_cmp_eq_u32 s14, 0
    s_cselect_b32 s38, s13, s38
    s_add_u32 s39, s14, 4
    s_cmp_eq_u32 s13, 3
    s_cselect_b32 s38, s39, s38
    s_mov_b32 s76, s38
    s_sub_u32 s39, s15, 1
    s_cmp_lt_u32 s39, 2
    s_cselect_b32 s11, 0, 2
    s_cmp_eq_u32 s15, 0
    s_cselect_b32 s11, 1, s11
    s_sub_u32 s39, s76, 3
    s_cmp_eq_u32 s11, 2
    s_cselect_b32 s39, s39, s15
    s_add_u32 s77, s39, s88
    s_and_b32 s77, s77, 3
    s_lshl_b32 s77, s77, 1
    s_and_b32 s78, s87, 1
    s_xor_b32 s78, s78, 1
    s_and_b32 s39, s88, 4
    s_cmp_eq_u32 s39, 0
    s_cselect_b32 s78, s78, 0
    s_cmp_le_u32 s76, 6
    s_cselect_b32 s39, 2, 0
    s_cmp_eq_u32 s11, 2
    s_cselect_b32 s39, s39, 0
    s_or_b32 s78, s78, s39
    s_mul_i32 s12, s38, 6
    s_mul_i32 s39, s38, 5
    s_add_u32 s39, s39, 3
    s_cmp_lt_u32 s38, 3
    s_cselect_b32 s12, s12, s39
    s_and_b32 s84, s88, 3
    s_lshl_b32 s39, s87, 2
    s_add_u32 s84, s84, s39
    s_lshr_b32 s85, s88, 2
    s_lshr_b32 s86, s84, 1
    s_cmp_lt_u32 s8, 4
    s_cbranch_scc1 L_cons
    s_cmp_eq_u32 s8, 7
    s_cbranch_scc1 L_serv
    v_lshrrev_b32 v2, 3, v0
    v_and_b32 v3, 7, v0
    v_lshrrev_b32 v4, 1, v2
    v_xor_b32 v5, v3, v4
    v_xor_b32 v6, 4, v5
    v_lshlrev_b32 v7, 11, v2
    v_lshl_add_u32 v8, v5, 4, v7
    v_lshl_add_u32 v9, v6, 4, v7
    s_lshl_b32 s13, s9, 17
    v_add_u32 v8, s13, v8
    v_add_u32 v9, s13, v9
    s_cmp_eq_u32 s8, 5
    s_cbranch_scc1 Lpx1_2
    s_cmp_eq_u32 s8, 6
    s_cbranch_scc1 Lpx2_3
    v_add_u32 v16, 0xffffc400, v8
    v_add_u32 v17, 0xffffc000, v9
    v_add_u32 v18, 0x0, v8
    v_add_u32 v19, 0x4000, v9
    v_add_u32 v20, 0x4400, v8
    v_add_u32 v21, 0x400, v9
    v_max_i32 v16, 0, v16
    v_max_i32 v17, 0, v17
    s_branch Lpxdone_1
Lpx1_2:
    v_add_u32 v16, 0x8000, v8
    v_add_u32 v17, 0xc000, v9
    v_add_u32 v18, 0xc400, v8
    v_add_u32 v19, 0x8400, v9
    v_add_u32 v20, 0x10000, v8
    v_add_u32 v21, 0x14000, v9
    s_branch Lpxdone_1
Lpx2_3:
    v_add_u32 v16, 0x14400, v8
    v_add_u32 v17, 0x10400, v9
    v_add_u32 v18, 0x18000, v8
    v_add_u32 v19, 0x1c000, v9
    v_add_u32 v20, 0x1c400, v8
    v_add_u32 v21, 0x18400, v9
Lpxdone_1:
    s_sub_u32 s14, s8, 4
    v_and_b32 v4, 1, v4
    s_cmp_lg_u32 s11, 0
    s_cbranch_scc1 Lpwmlp_4
    v_lshlrev_b32 v5, 1, v4
    v_xor_b32 v6, 4, v5
    v_xor_b32 v5, v3, v5
    v_xor_b32 v6, v3, v6
    s_movk_i32 s13, 3072
    v_mul_lo_u32 v7, v2, s13
    s_lshl_b32 s15, s14, 10
    s_lshl_b32 s38, s10, 7
    s_add_u32 s15, s15, s38
    v_add_u32 v7, s15, v7
    v_lshl_add_u32 v8, v5, 4, v7
    v_lshl_add_u32 v9, v6, 4, v7
    v_add_u32 v24, 0, v8
    v_add_u32 v25, 24576, v9
    v_add_u32 v26, 49152, v8
    v_add_u32 v27, 73728, v9
    v_add_u32 v28, 98304, v8
    v_add_u32 v29, 122880, v9
    v_add_u32 v30, 147456, v8
    v_add_u32 v31, 172032, v9
    s_mov_b32 s92, 196608
    s_branch Lpwdone_5
Lpwmlp_4:
    v_lshlrev_b32 v5, 2, v4
    v_xor_b32 v5, v3, v5
    s_movk_i32 s13, 2752
    v_mul_lo_u32 v7, v2, s13
    s_lshl_b32 s15, s14, 7
    s_lshl_b32 s38, s12, 6
    s_add_u32 s15, s15, s38
    v_add_u32 v7, s15, v7
    v_lshl_add_u32 v8, v5, 4, v7
    v_add_u32 v24, 0, v8
    v_add_u32 v25, 22016, v8
    v_add_u32 v26, 44032, v8
    v_add_u32 v27, 66048, v8
    v_add_u32 v28, 88064, v8
    v_add_u32 v29, 110080, v8
    v_add_u32 v30, 132096, v8
    v_add_u32 v31, 154112, v8
    s_mov_b32 s92, 176128
Lpwdone_5:
    s_mov_b64 s[68:69], -1
    s_cmp_lg_u32 s11, 2
    s_cbranch_scc1 Lpwnm_6
    s_cmp_lg_u32 s8, 6
    s_cbranch_scc1 Lpwnm_6
    v_cmp_gt_u32 s[68:69], 4, v5
Lpwnm_6:
    s_mul_i32 s66, s14, 6144
    s_lshl_b32 s67, s14, 13
    s_add_u32 s67, s67, 18432
    s_mov_b32 s60, 0
    s_lshl_b32 s61, s77, 7
    s_mul_i32 s62, s77, s92
    s_waitcnt lgkmcnt(0)
    s_mov_b32 s40, s16
    s_and_b32 s41, s17, 0xffff
    s_mov_b32 s42, 2097152
    s_mov_b32 s43, 0x20000
    s_cmp_eq_u32 s11, 0
    s_cselect_b32 s44, s18, s24
    s_cselect_b32 s45, s19, s25
    s_mov_b32 s46, 1409024
    s_cselect_b32 s46, 1572864, s46
    s_and_b32 s45, s45, 0xffff
    s_mov_b32 s47, 0x20000
    s_add_u32 s64, s36, 8650752
    s_addc_u32 s65, s37, 0
    s_cmp_eq_u32 s11, 0
    s_cbranch_scc1 L_prod14
    s_cmp_eq_u32 s8, 4
    s_cbranch_scc0 L_prod14
    s_add_u32 s13, s60, s66
    s_add_u32 m0, s13, 2048
    s_nop 0
    buffer_load_dwordx4 v18, s[40:43], s61 offen lds
    s_add_u32 m0, s13, 3072
    s_nop 0
    buffer_load_dwordx4 v19, s[40:43], s61 offen lds
    s_add_u32 m0, s13, 4096
    s_nop 0
    buffer_load_dwordx4 v20, s[40:43], s61 offen lds
    s_add_u32 m0, s13, 5120
    s_nop 0
    buffer_load_dwordx4 v21, s[40:43], s61 offen lds
    s_add_u32 s13, s60, s67
    s_mov_b64 exec, s[68:69]
    s_add_u32 m0, s13, 0
    s_nop 0
    buffer_load_dwordx4 v24, s[44:47], s62 offen lds
    s_add_u32 m0, s13, 1024
    s_nop 0
    buffer_load_dwordx4 v25, s[44:47], s62 offen lds
    s_add_u32 m0, s13, 2048
    s_nop 0
    buffer_load_dwordx4 v26, s[44:47], s62 offen lds
    s_add_u32 m0, s13, 3072
    s_nop 0
    buffer_load_dwordx4 v27, s[44:47], s62 offen lds
    s_add_u32 m0, s13, 4096
    s_nop 0
    buffer_load_dwordx4 v28, s[44:47], s62 offen lds
    s_add_u32 m0, s13, 5120
    s_nop 0
    buffer_load_dwordx4 v29, s[44:47], s62 offen lds
    s_add_u32 m0, s13, 6144
    s_nop 0
    buffer_load_dwordx4 v30, s[44:47], s62 offen lds
    s_add_u32 m0, s13, 7168
    s_nop 0
    buffer_load_dwordx4 v31, s[44:47], s62 offen lds
    s_mov_b64 exec, -1
    s_add_u32 s61, s61, 128
    s_add_u32 s62, s62, s92
    s_cmp_eq_u32 s61, 1024
    s_cselect_b32 s61, 0, s61
    s_cselect_b32 s62, 0, s62
    s_add_u32 s60, s60, 43008
    s_cmp_eq_u32 s60, 129024
    s_cselect_b32 s60, 0, s60
    s_barrier
    s_add_u32 s13, s60, s66
    s_add_u32 m0, s13, 2048
    s_nop 0
    buffer_load_dwordx4 v18, s[40:43], s61 offen lds
    s_add_u32 m0, s13, 3072
    s_nop 0
    buffer_load_dwordx4 v19, s[40:43], s61 offen lds
    s_add_u32 m0, s13, 4096
    s_nop 0
    buffer_load_dwordx4 v20, s[40:43], s61 offen lds
    s_add_u32 m0, s13, 5120
    s_nop 0
    buffer_load_dwordx4 v21, s[40:43], s61 offen lds
    s_add_u32 s13, s60, s67
    s_mov_b64 exec, s[68:69]
    s_add_u32 m0, s13, 0
    s_nop 0
    buffer_load_dwordx4 v24, s[44:47], s62 offen lds
    s_add_u32 m0, s13, 1024
    s_nop 0
    buffer_load_dwordx4 v25, s[44:47], s62 offen lds
    s_add_u32 m0, s13, 2048
    s_nop 0
    buffer_load_dwordx4 v26, s[44:47], s62 offen lds
    s_add_u32 m0, s13, 3072
    s_nop 0
    buffer_load_dwordx4 v27, s[44:47], s62 offen lds
    s_add_u32 m0, s13, 4096
    s_nop 0
    buffer_load_dwordx4 v28, s[44:47], s62 offen lds
    s_add_u32 m0, s13, 5120
    s_nop 0
    buffer_load_dwordx4 v29, s[44:47], s62 offen lds
    s_add_u32 m0, s13, 6144
    s_nop 0
    buffer_load_dwordx4 v30, s[44:47], s62 offen lds
    s_add_u32 m0, s13, 7168
    s_nop 0
    buffer_load_dwordx4 v31, s[44:47], s62 offen lds
    s_mov_b64 exec, -1
    s_add_u32 s61, s61, 128
    s_add_u32 s62, s62, s92
    s_cmp_eq_u32 s61, 1024
    s_cselect_b32 s61, 0, s61
    s_cselect_b32 s62, 0, s62
    s_add_u32 s60, s60, 43008
    s_cmp_eq_u32 s60, 129024
    s_cselect_b32 s60, 0, s60
    s_waitcnt vmcnt(12)
    s_barrier
    s_add_u32 s13, s60, s66
    s_add_u32 m0, s13, 2048
    s_nop 0
    buffer_load_dwordx4 v18, s[40:43], s61 offen lds
    s_add_u32 m0, s13, 3072
    s_nop 0
    buffer_load_dwordx4 v19, s[40:43], s61 offen lds
    s_add_u32 m0, s13, 4096
    s_nop 0
    buffer_load_dwordx4 v20, s[40:43], s61 offen lds
    s_add_u32 m0, s13, 5120
    s_nop 0
    buffer_load_dwordx4 v21, s[40:43], s61 offen lds
    s_add_u32 s13, s60, s67
    s_mov_b64 exec, s[68:69]
    s_add_u32 m0, s13, 0
    s_nop 0
    buffer_load_dwordx4 v24, s[44:47], s62 offen lds
    s_add_u32 m0, s13, 1024
    s_nop 0
    buffer_load_dwordx4 v25, s[44:47], s62 offen lds
    s_add_u32 m0, s13, 2048
    s_nop 0
    buffer_load_dwordx4 v26, s[44:47], s62 offen lds
    s_add_u32 m0, s13, 3072
    s_nop 0
    buffer_load_dwordx4 v27, s[44:47], s62 offen lds
    s_add_u32 m0, s13, 4096
    s_nop 0
    buffer_load_dwordx4 v28, s[44:47], s62 offen lds
    s_add_u32 m0, s13, 5120
    s_nop 0
    buffer_load_dwordx4 v29, s[44:47], s62 offen lds
    s_add_u32 m0, s13, 6144
    s_nop 0
    buffer_load_dwordx4 v30, s[44:47], s62 offen lds
    s_add_u32 m0, s13, 7168
    s_nop 0
    buffer_load_dwordx4 v31, s[44:47], s62 offen lds
    s_mov_b64 exec, -1
    s_add_u32 s61, s61, 128
    s_add_u32 s62, s62, s92
    s_cmp_eq_u32 s61, 1024
    s_cselect_b32 s61, 0, s61
    s_cselect_b32 s62, 0, s62
    s_add_u32 s60, s60, 43008
    s_cmp_eq_u32 s60, 129024
    s_cselect_b32 s60, 0, s60
    s_mov_b32 s63, 5
Lploopa_7:
    s_waitcnt vmcnt(12)
    s_barrier
    s_add_u32 s13, s60, s66
    s_add_u32 m0, s13, 2048
    s_nop 0
    buffer_load_dwordx4 v18, s[40:43], s61 offen lds
    s_add_u32 m0, s13, 3072
    s_nop 0
    buffer_load_dwordx4 v19, s[40:43], s61 offen lds
    s_add_u32 m0, s13, 4096
    s_nop 0
    buffer_load_dwordx4 v20, s[40:43], s61 offen lds
    s_add_u32 m0, s13, 5120
    s_nop 0
    buffer_load_dwordx4 v21, s[40:43], s61 offen lds
    s_add_u32 s13, s60, s67
    s_mov_b64 exec, s[68:69]
    s_add_u32 m0, s13, 0
    s_nop 0
    buffer_load_dwordx4 v24, s[44:47], s62 offen lds
    s_add_u32 m0, s13, 1024
    s_nop 0
    buffer_load_dwordx4 v25, s[44:47], s62 offen lds
    s_add_u32 m0, s13, 2048
    s_nop 0
    buffer_load_dwordx4 v26, s[44:47], s62 offen lds
    s_add_u32 m0, s13, 3072
    s_nop 0
    buffer_load_dwordx4 v27, s[44:47], s62 offen lds
    s_add_u32 m0, s13, 4096
    s_nop 0
    buffer_load_dwordx4 v28, s[44:47], s62 offen lds
    s_add_u32 m0, s13, 5120
    s_nop 0
    buffer_load_dwordx4 v29, s[44:47], s62 offen lds
    s_add_u32 m0, s13, 6144
    s_nop 0
    buffer_load_dwordx4 v30, s[44:47], s62 offen lds
    s_add_u32 m0, s13, 7168
    s_nop 0
    buffer_load_dwordx4 v31, s[44:47], s62 offen lds
    s_mov_b64 exec, -1
    s_add_u32 s61, s61, 128
    s_add_u32 s62, s62, s92
    s_cmp_eq_u32 s61, 1024
    s_cselect_b32 s61, 0, s61
    s_cselect_b32 s62, 0, s62
    s_add_u32 s60, s60, 43008
    s_cmp_eq_u32 s60, 129024
    s_cselect_b32 s60, 0, s60
    s_sub_u32 s63, s63, 1
    s_cmp_lg_u32 s63, 0
    s_cbranch_scc1 Lploopa_7
    s_branch L_prod_s1
L_prod14:
    s_add_u32 s13, s60, s66
    s_add_u32 m0, s13, 0
    s_nop 0
    buffer_load_dwordx4 v16, s[40:43], s61 offen lds
    s_add_u32 m0, s13, 1024
    s_nop 0
    buffer_load_dwordx4 v17, s[40:43], s61 offen lds
    s_add_u32 m0, s13, 2048
    s_nop 0
    buffer_load_dwordx4 v18, s[40:43], s61 offen lds
    s_add_u32 m0, s13, 3072
    s_nop 0
    buffer_load_dwordx4 v19, s[40:43], s61 offen lds
    s_add_u32 m0, s13, 4096
    s_nop 0
    buffer_load_dwordx4 v20, s[40:43], s61 offen lds
    s_add_u32 m0, s13, 5120
    s_nop 0
    buffer_load_dwordx4 v21, s[40:43], s61 offen lds
    s_add_u32 s13, s60, s67
    s_mov_b64 exec, s[68:69]
    s_add_u32 m0, s13, 0
    s_nop 0
    buffer_load_dwordx4 v24, s[44:47], s62 offen lds
    s_add_u32 m0, s13, 1024
    s_nop 0
    buffer_load_dwordx4 v25, s[44:47], s62 offen lds
    s_add_u32 m0, s13, 2048
    s_nop 0
    buffer_load_dwordx4 v26, s[44:47], s62 offen lds
    s_add_u32 m0, s13, 3072
    s_nop 0
    buffer_load_dwordx4 v27, s[44:47], s62 offen lds
    s_add_u32 m0, s13, 4096
    s_nop 0
    buffer_load_dwordx4 v28, s[44:47], s62 offen lds
    s_add_u32 m0, s13, 5120
    s_nop 0
    buffer_load_dwordx4 v29, s[44:47], s62 offen lds
    s_add_u32 m0, s13, 6144
    s_nop 0
    buffer_load_dwordx4 v30, s[44:47], s62 offen lds
    s_add_u32 m0, s13, 7168
    s_nop 0
    buffer_load_dwordx4 v31, s[44:47], s62 offen lds
    s_mov_b64 exec, -1
    s_add_u32 s61, s61, 128
    s_add_u32 s62, s62, s92
    s_cmp_eq_u32 s61, 1024
    s_cselect_b32 s61, 0, s61
    s_cselect_b32 s62, 0, s62
    s_add_u32 s60, s60, 43008
    s_cmp_eq_u32 s60, 129024
    s_cselect_b32 s60, 0, s60
    s_barrier
    s_add_u32 s13, s60, s66
    s_add_u32 m0, s13, 0
    s_nop 0
    buffer_load_dwordx4 v16, s[40:43], s61 offen lds
    s_add_u32 m0, s13, 1024
    s_nop 0
    buffer_load_dwordx4 v17, s[40:43], s61 offen lds
    s_add_u32 m0, s13, 2048
    s_nop 0
    buffer_load_dwordx4 v18, s[40:43], s61 offen lds
    s_add_u32 m0, s13, 3072
    s_nop 0
    buffer_load_dwordx4 v19, s[40:43], s61 offen lds
    s_add_u32 m0, s13, 4096
    s_nop 0
    buffer_load_dwordx4 v20, s[40:43], s61 offen lds
    s_add_u32 m0, s13, 5120
    s_nop 0
    buffer_load_dwordx4 v21, s[40:43], s61 offen lds
    s_add_u32 s13, s60, s67
    s_mov_b64 exec, s[68:69]
    s_add_u32 m0, s13, 0
    s_nop 0
    buffer_load_dwordx4 v24, s[44:47], s62 offen lds
    s_add_u32 m0, s13, 1024
    s_nop 0
    buffer_load_dwordx4 v25, s[44:47], s62 offen lds
    s_add_u32 m0, s13, 2048
    s_nop 0
    buffer_load_dwordx4 v26, s[44:47], s62 offen lds
    s_add_u32 m0, s13, 3072
    s_nop 0
    buffer_load_dwordx4 v27, s[44:47], s62 offen lds
    s_add_u32 m0, s13, 4096
    s_nop 0
    buffer_load_dwordx4 v28, s[44:47], s62 offen lds
    s_add_u32 m0, s13, 5120
    s_nop 0
    buffer_load_dwordx4 v29, s[44:47], s62 offen lds
    s_add_u32 m0, s13, 6144
    s_nop 0
    buffer_load_dwordx4 v30, s[44:47], s62 offen lds
    s_add_u32 m0, s13, 7168
    s_nop 0
    buffer_load_dwordx4 v31, s[44:47], s62 offen lds
    s_mov_b64 exec, -1
    s_add_u32 s61, s61, 128
    s_add_u32 s62, s62, s92
    s_cmp_eq_u32 s61, 1024
    s_cselect_b32 s61, 0, s61
    s_cselect_b32 s62, 0, s62
    s_add_u32 s60, s60, 43008
    s_cmp_eq_u32 s60, 129024
    s_cselect_b32 s60, 0, s60
    s_waitcnt vmcnt(14)
    s_barrier
    s_add_u32 s13, s60, s66
    s_add_u32 m0, s13, 0
    s_nop 0
    buffer_load_dwordx4 v16, s[40:43], s61 offen lds
    s_add_u32 m0, s13, 1024
    s_nop 0
    buffer_load_dwordx4 v17, s[40:43], s61 offen lds
    s_add_u32 m0, s13, 2048
    s_nop 0
    buffer_load_dwordx4 v18, s[40:43], s61 offen lds
    s_add_u32 m0, s13, 3072
    s_nop 0
    buffer_load_dwordx4 v19, s[40:43], s61 offen lds
    s_add_u32 m0, s13, 4096
    s_nop 0
    buffer_load_dwordx4 v20, s[40:43], s61 offen lds
    s_add_u32 m0, s13, 5120
    s_nop 0
    buffer_load_dwordx4 v21, s[40:43], s61 offen lds
    s_add_u32 s13, s60, s67
    s_mov_b64 exec, s[68:69]
    s_add_u32 m0, s13, 0
    s_nop 0
    buffer_load_dwordx4 v24, s[44:47], s62 offen lds
    s_add_u32 m0, s13, 1024
    s_nop 0
    buffer_load_dwordx4 v25, s[44:47], s62 offen lds
    s_add_u32 m0, s13, 2048
    s_nop 0
    buffer_load_dwordx4 v26, s[44:47], s62 offen lds
    s_add_u32 m0, s13, 3072
    s_nop 0
    buffer_load_dwordx4 v27, s[44:47], s62 offen lds
    s_add_u32 m0, s13, 4096
    s_nop 0
    buffer_load_dwordx4 v28, s[44:47], s62 offen lds
    s_add_u32 m0, s13, 5120
    s_nop 0
    buffer_load_dwordx4 v29, s[44:47], s62 offen lds
    s_add_u32 m0, s13, 6144
    s_nop 0
    buffer_load_dwordx4 v30, s[44:47], s62 offen lds
    s_add_u32 m0, s13, 7168
    s_nop 0
    buffer_load_dwordx4 v31, s[44:47], s62 offen lds
    s_mov_b64 exec, -1
    s_add_u32 s61, s61, 128
    s_add_u32 s62, s62, s92
    s_cmp_eq_u32 s61, 1024
    s_cselect_b32 s61, 0, s61
    s_cselect_b32 s62, 0, s62
    s_add_u32 s60, s60, 43008
    s_cmp_eq_u32 s60, 129024
    s_cselect_b32 s60, 0, s60
    s_mov_b32 s63, 5
Lploopb_8:
    s_waitcnt vmcnt(14)
    s_barrier
    s_add_u32 s13, s60, s66
    s_add_u32 m0, s13, 0
    s_nop 0
    buffer_load_dwordx4 v16, s[40:43], s61 offen lds
    s_add_u32 m0, s13, 1024
    s_nop 0
    buffer_load_dwordx4 v17, s[40:43], s61 offen lds
    s_add_u32 m0, s13, 2048
    s_nop 0
    buffer_load_dwordx4 v18, s[40:43], s61 offen lds
    s_add_u32 m0, s13, 3072
    s_nop 0
    buffer_load_dwordx4 v19, s[40:43], s61 offen lds
    s_add_u32 m0, s13, 4096
    s_nop 0
    buffer_load_dwordx4 v20, s[40:43], s61 offen lds
    s_add_u32 m0, s13, 5120
    s_nop 0
    buffer_load_dwordx4 v21, s[40:43], s61 offen lds
    s_add_u32 s13, s60, s67
    s_mov_b64 exec, s[68:69]
    s_add_u32 m0, s13, 0
    s_nop 0
    buffer_load_dwordx4 v24, s[44:47], s62 offen lds
    s_add_u32 m0, s13, 1024
    s_nop 0
    buffer_load_dwordx4 v25, s[44:47], s62 offen lds
    s_add_u32 m0, s13, 2048
    s_nop 0
    buffer_load_dwordx4 v26, s[44:47], s62 offen lds
    s_add_u32 m0, s13, 3072
    s_nop 0
    buffer_load_dwordx4 v27, s[44:47], s62 offen lds
    s_add_u32 m0, s13, 4096
    s_nop 0
    buffer_load_dwordx4 v28, s[44:47], s62 offen lds
    s_add_u32 m0, s13, 5120
    s_nop 0
    buffer_load_dwordx4 v29, s[44:47], s62 offen lds
    s_add_u32 m0, s13, 6144
    s_nop 0
    buffer_load_dwordx4 v30, s[44:47], s62 offen lds
    s_add_u32 m0, s13, 7168
    s_nop 0
    buffer_load_dwordx4 v31, s[44:47], s62 offen lds
    s_mov_b64 exec, -1
    s_add_u32 s61, s61, 128
    s_add_u32 s62, s62, s92
    s_cmp_eq_u32 s61, 1024
    s_cselect_b32 s61, 0, s61
    s_cselect_b32 s62, 0, s62
    s_add_u32 s60, s60, 43008
    s_cmp_eq_u32 s60, 129024
    s_cselect_b32 s60, 0, s60
    s_sub_u32 s63, s63, 1
    s_cmp_lg_u32 s63, 0
    s_cbranch_scc1 Lploopb_8
    s_branch L_prod_s1
L_prod_s1:
    s_sub_u32 s14, s8, 4
    s_lshl_b32 s13, s9, 7
    s_lshl_b32 s15, s14, 6
    s_cmp_eq_u32 s14, 2
    s_cselect_b32 s38, 15, 63
    v_and_b32 v69, s38, v0
    v_add_u32 v69, s15, v69
    v_add_u32 v70, -16, v69
    v_add_u32 v71, -32, v69
    v_cmp_gt_u32 vcc, 8, v69
    s_nop 1
    v_cndmask_b32_e64 v71, v71, v70, vcc
    v_cmp_gt_u32 vcc, 16, v69
    s_nop 1
    v_cndmask_b32_e64 v70, v70, v71, vcc
    v_add_u32 v70, s13, v70
    v_max_i32 v70, 0, v70
    v_lshlrev_b32 v70, 4, v70
    v_add_u32 v66, 7864320, v70
    s_cmp_lg_u32 s11, 0
    s_cbranch_scc1 Ls1m_9
    s_lshl_b32 s13, s10, 6
    s_lshl_b32 s15, s14, 9
    s_add_u32 s13, s13, s15
    v_add_u32 v67, s13, v0
    v_mov_b32 v68, 0
    s_branch Ls1d_10
Ls1m_9:
    s_cmp_eq_u32 s11, 2
    s_cselect_b32 s38, 31, 63
    s_cmp_eq_u32 s14, 2
    s_cselect_b32 s38, s38, 63
    v_and_b32 v68, s38, v0
    s_lshl_b32 s13, s12, 5
    s_add_u32 s13, s13, s15
    v_add_u32 v68, s13, v68
    v_add_u32 v67, 1536, v68
    v_lshlrev_b32 v68, 1, v68
Ls1d_10:
    v_lshlrev_b32 v67, 3, v67
    v_add_u32 v67, 8454144, v67
    s_waitcnt vmcnt(12)
    s_barrier
    global_load_dwordx4 v[32:35], v66, s[36:37] sc1
    v_add_u32 v66, 32768, v66
    global_load_dwordx4 v[36:39], v66, s[36:37] sc1
    v_add_u32 v66, 32768, v66
    global_load_dwordx4 v[40:43], v66, s[36:37] sc1
    v_add_u32 v66, 32768, v66
    global_load_dwordx4 v[44:47], v66, s[36:37] sc1
    v_subrev_u32 v66, 98304, v66
    global_load_dwordx2 v[48:49], v67, s[36:37] sc1
    v_add_u32 v67, 23552, v67
    global_load_dwordx2 v[50:51], v67, s[36:37] sc1
    v_add_u32 v67, 23552, v67
    global_load_dwordx2 v[52:53], v67, s[36:37] sc1
    v_add_u32 v67, 23552, v67
    global_load_dwordx2 v[54:55], v67, s[36:37] sc1
    v_subrev_u32 v67, 70656, v67
    global_load_ushort v64, v68, s[26:27]
    s_mov_b32 s52, s20
    s_and_b32 s53, s21, 0xffff
    s_mov_b32 s54, 524288
    s_mov_b32 s55, 0x20000
    s_mov_b32 s56, s28
    s_and_b32 s57, s29, 0xffff
    s_mov_b32 s58, 1409024
    s_mov_b32 s59, 0x20000
    s_sub_u32 s14, s8, 4
    s_and_b32 s15, s88, 3
    s_mul_i32 s13, s14, 192
    v_add_u32 v8, s13, v0
    v_mul_u32_u24 v8, 4, v8
    v_add_u32 v8, s15, v8
    s_lshl_b32 s13, s85, 7
    v_lshlrev_b32 v9, 10, v8
    v_add_u32 v9, s13, v9
    v_cmp_gt_u32 vcc, 512, v8
    s_nop 0
    s_cmp_eq_u64 vcc, 0
    s_cbranch_scc1 Lbt2_11
    buffer_load_dword v10, v9, s[52:55], 0 offen
    s_branch Lbtd_12
Lbt2_11:
    v_add_u32 v9, 0xfff80000, v9
    buffer_load_dword v16, v9, s[56:59], 0 offen
Lbtd_12:
    v_add_u32 v8, 256, v8
    v_lshlrev_b32 v9, 10, v8
    v_add_u32 v9, s13, v9
    v_cmp_gt_u32 vcc, 512, v8
    s_nop 0
    s_cmp_eq_u64 vcc, 0
    s_cbranch_scc1 Lbt2_13
    buffer_load_dword v11, v9, s[52:55], 0 offen
    s_branch Lbtd_14
Lbt2_13:
    v_add_u32 v9, 0xfff80000, v9
    buffer_load_dword v17, v9, s[56:59], 0 offen
Lbtd_14:
    v_add_u32 v8, 256, v8
    v_lshlrev_b32 v9, 10, v8
    v_add_u32 v9, s13, v9
    v_cmp_gt_u32 vcc, 512, v8
    s_nop 0
    s_cmp_eq_u64 vcc, 0
    s_cbranch_scc1 Lbt2_15
    buffer_load_dword v12, v9, s[52:55], 0 offen
    s_branch Lbtd_16
Lbt2_15:
    v_add_u32 v9, 0xfff80000, v9
    buffer_load_dword v18, v9, s[56:59], 0 offen
Lbtd_16:
    s_lshl_b32 s13, s84, 16
    v_mov_b32 v14, s13
    v_mov_b32 v13, 0
    s_mov_b64 s[90:91], exec
    s_mov_b64 exec, 1
    global_load_dword v14, v14, s[32:33]
    global_load_dword v13, v13, s[30:31]
    s_mov_b64 exec, s[90:91]
    s_waitcnt vmcnt(14)
    s_barrier
    s_mov_b32 s63, 0
    s_mov_b32 s92, 0
    s_waitcnt vmcnt(5)
    s_call_b64 s[98:99], L_s1step
    s_barrier
Ls1l_17:
    s_cmp_eq_u32 s63, 1
    s_cbranch_scc1 Ls1x_18
    s_add_u32 s92, s92, 1
    s_cmp_gt_u32 s92, 524288
    s_cbranch_scc1 Ls1x_18
    s_waitcnt vmcnt(0)
    s_call_b64 s[98:99], L_s1step
    s_branch Ls1l_17
Ls1x_18:
    s_branch L_tail
L_serv:
    s_waitcnt lgkmcnt(0)
    s_mov_b32 s40, s16
    s_and_b32 s41, s17, 0xffff
    s_mov_b32 s42, 2097152
    s_mov_b32 s43, 0x20000
    s_cmp_eq_u32 s11, 0
    s_cselect_b32 s44, s18, s24
    s_cselect_b32 s45, s19, s25
    s_mov_b32 s46, 1409024
    s_cselect_b32 s46, 1572864, s46
    s_and_b32 s45, s45, 0xffff
    s_mov_b32 s47, 0x20000
    s_add_u32 s64, s36, 8650752
    s_addc_u32 s65, s37, 0
    v_mov_b32 v20, 0
    s_cmp_lg_u32 s2, 0
    s_cbranch_scc1 Lnotag_20
    s_memrealtime s[98:99]
    s_waitcnt lgkmcnt(0)
    s_or_b32 s98, s98, 1
    v_mov_b32 v24, s98
    v_mov_b32 v25, 0
    s_mov_b64 s[90:91], exec
    s_mov_b64 exec, 1
    global_atomic_cmpswap v20, v[24:25], s[34:35] sc1
    s_mov_b64 exec, s[90:91]
Lnotag_20:
    v_mov_b32 v22, 163648
    v_mov_b32 v24, 0
    ds_write_b32 v22, v24 offset:0
    ds_write_b32 v22, v24 offset:4
    ds_write_b32 v22, v24 offset:8
    ds_write_b32 v22, v24 offset:12
    ds_write_b32 v22, v24 offset:16
    ds_write_b32 v22, v24 offset:20
    ds_write_b32 v22, v24 offset:24
    ds_write_b32 v22, v24 offset:28
    ds_write_b32 v22, v24 offset:32
    ds_write_b32 v22, v24 offset:36
    ds_write_b32 v22, v24 offset:40
    ds_write_b32 v22, v24 offset:44
    v_lshlrev_b32 v30, 4, v0
    v_add_u32 v30, 132096, v30
    v_mov_b32 v24, 0
    v_mov_b32 v25, 0
    v_mov_b32 v26, 0
    v_mov_b32 v27, 0
    ds_write_b128 v30, v[24:27] offset:0
    ds_write_b128 v30, v[24:27] offset:1024
    ds_write_b128 v30, v[24:27] offset:2048
    ds_write_b128 v30, v[24:27] offset:3072
    ds_write_b128 v30, v[24:27] offset:4096
    ds_write_b128 v30, v[24:27] offset:5120
    s_waitcnt lgkmcnt(0)
    s_barrier
    global_load_dword v21, v20, s[34:35] sc1
    s_cmp_lg_u32 s11, 0
    s_cbranch_scc1 Lssm_21
    s_lshl_b32 s13, s10, 6
    v_add_u32 v36, s13, v0
    v_add_u32 v36, 0, v36
    v_add_u32 v37, s13, v0
    v_add_u32 v37, 512, v37
    v_add_u32 v38, s13, v0
    v_add_u32 v38, 1024, v38
    v_mov_b32 v47, v0
    s_branch Lssd_22
Lssm_21:
    s_lshl_b32 s13, s12, 5
    s_add_u32 s13, s13, 1536
    s_cmp_eq_u32 s11, 2
    s_cselect_b32 s14, 31, 63
    v_and_b32 v47, s14, v0
    v_add_u32 v36, s13, v0
    v_add_u32 v36, 0, v36
    v_add_u32 v37, s13, v0
    v_add_u32 v37, 64, v37
    v_add_u32 v38, s13, v47
    v_add_u32 v38, 128, v38
Lssd_22:
    s_mul_i32 s13, s77, 11776
    s_add_u32 s13, s13, 8454144
    v_lshlrev_b32 v36, 3, v36
    v_add_u32 v36, s13, v36
    v_lshlrev_b32 v37, 3, v37
    v_add_u32 v37, s13, v37
    v_lshlrev_b32 v38, 3, v38
    v_add_u32 v38, s13, v38
    s_barrier
    s_waitcnt vmcnt(0)
    v_readfirstlane_b32 s75, v21
    s_nop 0
    s_cmp_lg_u32 s75, 0
    s_cbranch_scc1 Lsvt1_23
    global_load_dword v21, v20, s[34:35] sc1
    s_branch Lsvt2_24
Lsvt1_23:
    v_mov_b32 v22, 163660
    v_mov_b32 v24, s75
    ds_write_b32 v22, v24
    s_waitcnt lgkmcnt(0)
Lsvt2_24:
    s_barrier
    s_barrier
    s_cmp_lg_u32 s75, 0
    s_cbranch_scc1 Lsvtag_25
    s_waitcnt vmcnt(0)
    v_readfirstlane_b32 s75, v21
    s_nop 0
    s_cmp_lg_u32 s75, 0
    s_cbranch_scc1 Lsvtag2_26
    s_mov_b32 s95, 0
Lspintag_27:
    global_load_dword v21, v20, s[34:35] sc1
    s_waitcnt vmcnt(0)
    v_readfirstlane_b32 s75, v21
    s_nop 0
    s_cmp_lg_u32 s75, 0
    s_cbranch_scc1 Lgottag_28
    s_add_u32 s95, s95, 1
    s_cmp_gt_u32 s95, 524288
    s_cbranch_scc1 Lgottag_28
    s_sleep 1
    s_branch Lspintag_27
Lgottag_28:
Lsvtag2_26:
    v_mov_b32 v22, 163660
    v_mov_b32 v24, s75
    ds_write_b32 v22, v24
Lsvtag_25:
    s_waitcnt lgkmcnt(0)
    s_and_b32 s13, s78, 1
    s_cbranch_scc0 Lcfn_29
    v_mov_b32 v22, 163680
    s_mov_b32 s95, 0
Lcfl_30:
    ds_read_b128 v[24:27], v22
    s_waitcnt lgkmcnt(0)
    v_add_u32 v24, v24, v25
    v_add3_u32 v24, v24, v26, v27
    s_nop 0
    v_readfirstlane_b32 s94, v24
    s_nop 0
    s_cmp_eq_u32 s94, 4
    s_cbranch_scc1 Lcfg_31
    s_add_u32 s95, s95, 1
    s_cmp_gt_u32 s95, 8388608
    s_cbranch_scc0 Lcfl_30
Lcfg_31:
    s_and_b32 s13, s78, 1
    s_cbranch_scc0 Lspc_32
    v_lshlrev_b32 v30, 2, v0
    v_add_u32 v30, 132096, v30
    v_lshlrev_b32 v31, 2, v47
    v_add_u32 v31, 132096, v31
    ds_read_b32 v160, v30 offset:0
    ds_read_b32 v161, v30 offset:768
    ds_read_b32 v162, v30 offset:1536
    ds_read_b32 v163, v30 offset:2304
    ds_read_b32 v164, v30 offset:3072
    ds_read_b32 v165, v30 offset:3840
    ds_read_b32 v166, v30 offset:4608
    ds_read_b32 v167, v30 offset:5376
    ds_read_b32 v168, v30 offset:256
    ds_read_b32 v169, v30 offset:1024
    ds_read_b32 v170, v30 offset:1792
    ds_read_b32 v171, v30 offset:2560
    ds_read_b32 v172, v30 offset:3328
    ds_read_b32 v173, v30 offset:4096
    ds_read_b32 v174, v30 offset:4864
    ds_read_b32 v175, v30 offset:5632
    ds_read_b32 v176, v31 offset:512
    ds_read_b32 v177, v31 offset:1280
    ds_read_b32 v178, v31 offset:2048
    ds_read_b32 v179, v31 offset:2816
    ds_read_b32 v180, v31 offset:3584
    ds_read_b32 v181, v31 offset:4352
    ds_read_b32 v182, v31 offset:5120
    ds_read_b32 v183, v31 offset:5888
    s_waitcnt lgkmcnt(15)
    v_add_f32 v160, v160, v161
    v_add_f32 v160, v160, v162
    v_add_f32 v160, v160, v163
    v_add_f32 v160, v160, v164
    v_add_f32 v160, v160, v165
    v_add_f32 v160, v160, v166
    v_add_f32 v160, v160, v167
    v_mov_b32 v24, v160
    s_waitcnt lgkmcnt(14)
    v_add_f32 v168, v168, v169
    s_waitcnt lgkmcnt(13)
    v_add_f32 v168, v168, v170
    s_waitcnt lgkmcnt(12)
    v_add_f32 v168, v168, v171
    s_waitcnt lgkmcnt(11)
    v_add_f32 v168, v168, v172
    s_waitcnt lgkmcnt(10)
    v_add_f32 v168, v168, v173
    s_waitcnt lgkmcnt(9)
    v_add_f32 v168, v168, v174
    s_waitcnt lgkmcnt(8)
    v_add_f32 v168, v168, v175
    v_mov_b32 v26, v168
    s_waitcnt lgkmcnt(6)
    v_add_f32 v176, v176, v177
    s_waitcnt lgkmcnt(5)
    v_add_f32 v176, v176, v178
    s_waitcnt lgkmcnt(4)
    v_add_f32 v176, v176, v179
    s_waitcnt lgkmcnt(3)
    v_add_f32 v176, v176, v180
    s_waitcnt lgkmcnt(2)
    v_add_f32 v176, v176, v181
    s_waitcnt lgkmcnt(1)
    v_add_f32 v176, v176, v182
    s_waitcnt lgkmcnt(0)
    v_add_f32 v176, v176, v183
    v_mov_b32 v28, v176
    v_mov_b32 v25, s75
    v_mov_b32 v27, s75
    v_mov_b32 v29, s75
    global_store_dwordx2 v36, v[24:25], s[36:37] sc1
    global_store_dwordx2 v37, v[26:27], s[36:37] sc1
    global_store_dwordx2 v38, v[28:29], s[36:37] sc1
Lspc_32:
Lcfn_29:
    s_waitcnt lgkmcnt(0)
    s_barrier
    s_barrier
    s_barrier
    s_barrier
    s_barrier
    s_barrier
L_tail:
    v_lshrrev_b32 v2, 3, v0
    v_and_b32 v3, 7, v0
    v_lshrrev_b32 v4, 1, v2
    v_and_b32 v4, 1, v4
    v_lshlrev_b32 v4, 2, v4
    v_xor_b32 v4, v3, v4
    v_lshlrev_b32 v5, 10, v2
    v_lshl_add_u32 v5, v4, 4, v5
    s_lshl_b32 s13, s85, 7
    v_add_u32 v5, s13, v5
    v_add_u32 v6, 8192, v5
    s_mov_b32 s52, s20
    s_and_b32 s53, s21, 0xffff
    s_mov_b32 s54, 524288
    s_mov_b32 s55, 0x20000
    s_mov_b32 s56, s28
    s_and_b32 s57, s29, 0xffff
    s_mov_b32 s58, 1409024
    s_mov_b32 s59, 0x20000
    s_cmp_eq_u32 s11, 2
    s_cbranch_scc1 Lbm5_33
    s_sub_u32 s14, s8, 4
    s_mul_i32 s15, s14, 36864
    s_lshl_b32 s39, s14, 14
    s_add_u32 s38, s39, 589824
    s_add_u32 m0, s15, 0
    s_nop 0
    buffer_load_dwordx4 v5, s[56:59], s38 offen lds
    s_add_u32 m0, s15, 1024
    s_nop 0
    buffer_load_dwordx4 v6, s[56:59], s38 offen lds
    s_waitcnt vmcnt(10)
    s_add_u32 s38, s39, 655360
    s_add_u32 m0, s15, 2048
    s_nop 0
    buffer_load_dwordx4 v5, s[56:59], s38 offen lds
    s_add_u32 m0, s15, 3072
    s_nop 0
    buffer_load_dwordx4 v6, s[56:59], s38 offen lds
    s_waitcnt vmcnt(10)
    s_add_u32 s38, s39, 720896
    s_add_u32 m0, s15, 4096
    s_nop 0
    buffer_load_dwordx4 v5, s[56:59], s38 offen lds
    s_add_u32 m0, s15, 5120
    s_nop 0
    buffer_load_dwordx4 v6, s[56:59], s38 offen lds
    s_waitcnt vmcnt(10)
    s_add_u32 s38, s39, 786432
    s_add_u32 m0, s15, 6144
    s_nop 0
    buffer_load_dwordx4 v5, s[56:59], s38 offen lds
    s_add_u32 m0, s15, 7168
    s_nop 0
    buffer_load_dwordx4 v6, s[56:59], s38 offen lds
    s_waitcnt vmcnt(10)
    s_add_u32 s38, s39, 851968
    s_add_u32 m0, s15, 8192
    s_nop 0
    buffer_load_dwordx4 v5, s[56:59], s38 offen lds
    s_add_u32 m0, s15, 9216
    s_nop 0
    buffer_load_dwordx4 v6, s[56:59], s38 offen lds
    s_waitcnt vmcnt(10)
    s_add_u32 s38, s39, 917504
    s_add_u32 m0, s15, 10240
    s_nop 0
    buffer_load_dwordx4 v5, s[56:59], s38 offen lds
    s_add_u32 m0, s15, 11264
    s_nop 0
    buffer_load_dwordx4 v6, s[56:59], s38 offen lds
    s_waitcnt vmcnt(10)
    s_add_u32 s38, s39, 983040
    s_add_u32 m0, s15, 12288
    s_nop 0
    buffer_load_dwordx4 v5, s[56:59], s38 offen lds
    s_add_u32 m0, s15, 13312
    s_nop 0
    buffer_load_dwordx4 v6, s[56:59], s38 offen lds
    s_waitcnt vmcnt(10)
    s_add_u32 s38, s39, 1048576
    s_add_u32 m0, s15, 14336
    s_nop 0
    buffer_load_dwordx4 v5, s[56:59], s38 offen lds
    s_add_u32 m0, s15, 15360
    s_nop 0
    buffer_load_dwordx4 v6, s[56:59], s38 offen lds
    s_waitcnt vmcnt(10)
    s_add_u32 s38, s39, 1114112
    s_add_u32 m0, s15, 16384
    s_nop 0
    buffer_load_dwordx4 v5, s[56:59], s38 offen lds
    s_add_u32 m0, s15, 17408
    s_nop 0
    buffer_load_dwordx4 v6, s[56:59], s38 offen lds
    s_waitcnt vmcnt(10)
    s_add_u32 s38, s39, 1179648
    s_add_u32 m0, s15, 18432
    s_nop 0
    buffer_load_dwordx4 v5, s[56:59], s38 offen lds
    s_add_u32 m0, s15, 19456
    s_nop 0
    buffer_load_dwordx4 v6, s[56:59], s38 offen lds
    s_waitcnt vmcnt(10)
    s_add_u32 s38, s39, 1245184
    s_add_u32 m0, s15, 20480
    s_nop 0
    buffer_load_dwordx4 v5, s[56:59], s38 offen lds
    s_add_u32 m0, s15, 21504
    s_nop 0
    buffer_load_dwordx4 v6, s[56:59], s38 offen lds
    s_waitcnt vmcnt(10)
    s_add_u32 s38, s39, 1310720
    s_add_u32 m0, s15, 22528
    s_nop 0
    buffer_load_dwordx4 v5, s[56:59], s38 offen lds
    s_add_u32 m0, s15, 23552
    s_nop 0
    buffer_load_dwordx4 v6, s[56:59], s38 offen lds
    s_waitcnt vmcnt(10)
    s_add_u32 s38, s39, 1376256
    s_add_u32 m0, s15, 24576
    s_nop 0
    buffer_load_dwordx4 v5, s[56:59], s38 offen lds
    s_add_u32 m0, s15, 25600
    s_nop 0
    buffer_load_dwordx4 v6, s[56:59], s38 offen lds
    s_waitcnt vmcnt(10)
    s_add_u32 s38, s39, 0
    s_add_u32 m0, s15, 26624
    s_nop 0
    buffer_load_dwordx4 v5, s[52:55], s38 offen lds
    s_add_u32 m0, s15, 27648
    s_nop 0
    buffer_load_dwordx4 v6, s[52:55], s38 offen lds
    s_waitcnt vmcnt(10)
    s_add_u32 s38, s39, 65536
    s_add_u32 m0, s15, 28672
    s_nop 0
    buffer_load_dwordx4 v5, s[52:55], s38 offen lds
    s_add_u32 m0, s15, 29696
    s_nop 0
    buffer_load_dwordx4 v6, s[52:55], s38 offen lds
    s_waitcnt vmcnt(10)
    s_add_u32 s38, s39, 131072
    s_add_u32 m0, s15, 30720
    s_nop 0
    buffer_load_dwordx4 v5, s[52:55], s38 offen lds
    s_add_u32 m0, s15, 31744
    s_nop 0
    buffer_load_dwordx4 v6, s[52:55], s38 offen lds
    s_waitcnt vmcnt(10)
    s_add_u32 s38, s39, 196608
    s_add_u32 m0, s15, 32768
    s_nop 0
    buffer_load_dwordx4 v5, s[52:55], s38 offen lds
    s_add_u32 m0, s15, 33792
    s_nop 0
    buffer_load_dwordx4 v6, s[52:55], s38 offen lds
    s_waitcnt vmcnt(10)
    s_add_u32 s38, s39, 262144
    s_add_u32 m0, s15, 34816
    s_nop 0
    buffer_load_dwordx4 v5, s[52:55], s38 offen lds
    s_add_u32 m0, s15, 35840
    s_nop 0
    buffer_load_dwordx4 v6, s[52:55], s38 offen lds
    s_waitcnt vmcnt(10)
    s_sub_u32 s14, s8, 4
    s_lshl_b32 s39, s14, 14
    s_add_u32 s38, s39, 327680
    buffer_load_dwordx4 v[80:83], v5, s[52:55], s38 offen
    buffer_load_dwordx4 v[84:87], v6, s[52:55], s38 offen
    s_waitcnt vmcnt(10)
    s_add_u32 s38, s39, 393216
    buffer_load_dwordx4 v[88:91], v5, s[52:55], s38 offen
    buffer_load_dwordx4 v[92:95], v6, s[52:55], s38 offen
    s_waitcnt vmcnt(10)
    s_add_u32 s38, s39, 458752
    buffer_load_dwordx4 v[96:99], v5, s[52:55], s38 offen
    buffer_load_dwordx4 v[100:103], v6, s[52:55], s38 offen
    s_waitcnt vmcnt(10)
    s_add_u32 s38, s39, 0
    buffer_load_dwordx4 v[104:107], v5, s[56:59], s38 offen
    buffer_load_dwordx4 v[108:111], v6, s[56:59], s38 offen
    s_waitcnt vmcnt(10)
    s_add_u32 s38, s39, 65536
    buffer_load_dwordx4 v[112:115], v5, s[56:59], s38 offen
    buffer_load_dwordx4 v[116:119], v6, s[56:59], s38 offen
    s_waitcnt vmcnt(10)
    s_add_u32 s38, s39, 131072
    buffer_load_dwordx4 v[120:123], v5, s[56:59], s38 offen
    buffer_load_dwordx4 v[124:127], v6, s[56:59], s38 offen
    s_waitcnt vmcnt(10)
    s_add_u32 s38, s39, 196608
    buffer_load_dwordx4 v[128:131], v5, s[56:59], s38 offen
    buffer_load_dwordx4 v[132:135], v6, s[56:59], s38 offen
    s_waitcnt vmcnt(10)
    s_add_u32 s38, s39, 262144
    buffer_load_dwordx4 v[136:139], v5, s[56:59], s38 offen
    buffer_load_dwordx4 v[140:143], v6, s[56:59], s38 offen
    s_waitcnt vmcnt(10)
    s_add_u32 s38, s39, 327680
    buffer_load_dwordx4 v[144:147], v5, s[56:59], s38 offen
    buffer_load_dwordx4 v[148:151], v6, s[56:59], s38 offen
    s_waitcnt vmcnt(10)
    s_add_u32 s38, s39, 393216
    buffer_load_dwordx4 v[152:155], v5, s[56:59], s38 offen
    buffer_load_dwordx4 v[156:159], v6, s[56:59], s38 offen
    s_waitcnt vmcnt(10)
    s_add_u32 s38, s39, 458752
    buffer_load_dwordx4 v[160:163], v5, s[56:59], s38 offen
    buffer_load_dwordx4 v[164:167], v6, s[56:59], s38 offen
    s_waitcnt vmcnt(10)
    s_add_u32 s38, s39, 524288
    buffer_load_dwordx4 v[168:171], v5, s[56:59], s38 offen
    buffer_load_dwordx4 v[172:175], v6, s[56:59], s38 offen
    s_waitcnt vmcnt(10)
    s_waitcnt vmcnt(0)
    s_branch Lbdn_34
Lbm5_33:
    s_sub_u32 s14, s8, 4
    s_mul_i32 s15, s14, 36864
    s_lshl_b32 s39, s14, 14
    s_add_u32 s38, s39, 589824
    s_add_u32 m0, s15, 0
    s_nop 0
    buffer_load_dwordx4 v5, s[56:59], s38 offen lds
    s_add_u32 m0, s15, 1024
    s_nop 0
    buffer_load_dwordx4 v6, s[56:59], s38 offen lds
    s_waitcnt vmcnt(6)
    s_add_u32 s38, s39, 655360
    s_add_u32 m0, s15, 2048
    s_nop 0
    buffer_load_dwordx4 v5, s[56:59], s38 offen lds
    s_add_u32 m0, s15, 3072
    s_nop 0
    buffer_load_dwordx4 v6, s[56:59], s38 offen lds
    s_waitcnt vmcnt(6)
    s_add_u32 s38, s39, 720896
    s_add_u32 m0, s15, 4096
    s_nop 0
    buffer_load_dwordx4 v5, s[56:59], s38 offen lds
    s_add_u32 m0, s15, 5120
    s_nop 0
    buffer_load_dwordx4 v6, s[56:59], s38 offen lds
    s_waitcnt vmcnt(6)
    s_add_u32 s38, s39, 786432
    s_add_u32 m0, s15, 6144
    s_nop 0
    buffer_load_dwordx4 v5, s[56:59], s38 offen lds
    s_add_u32 m0, s15, 7168
    s_nop 0
    buffer_load_dwordx4 v6, s[56:59], s38 offen lds
    s_waitcnt vmcnt(6)
    s_add_u32 s38, s39, 851968
    s_add_u32 m0, s15, 8192
    s_nop 0
    buffer_load_dwordx4 v5, s[56:59], s38 offen lds
    s_add_u32 m0, s15, 9216
    s_nop 0
    buffer_load_dwordx4 v6, s[56:59], s38 offen lds
    s_waitcnt vmcnt(6)
    s_add_u32 s38, s39, 917504
    s_add_u32 m0, s15, 10240
    s_nop 0
    buffer_load_dwordx4 v5, s[56:59], s38 offen lds
    s_add_u32 m0, s15, 11264
    s_nop 0
    buffer_load_dwordx4 v6, s[56:59], s38 offen lds
    s_waitcnt vmcnt(6)
    s_add_u32 s38, s39, 983040
    s_add_u32 m0, s15, 12288
    s_nop 0
    buffer_load_dwordx4 v5, s[56:59], s38 offen lds
    s_add_u32 m0, s15, 13312
    s_nop 0
    buffer_load_dwordx4 v6, s[56:59], s38 offen lds
    s_waitcnt vmcnt(6)
    s_add_u32 s38, s39, 1048576
    s_add_u32 m0, s15, 14336
    s_nop 0
    buffer_load_dwordx4 v5, s[56:59], s38 offen lds
    s_add_u32 m0, s15, 15360
    s_nop 0
    buffer_load_dwordx4 v6, s[56:59], s38 offen lds
    s_waitcnt vmcnt(6)
    s_add_u32 s38, s39, 1114112
    s_add_u32 m0, s15, 16384
    s_nop 0
    buffer_load_dwordx4 v5, s[56:59], s38 offen lds
    s_add_u32 m0, s15, 17408
    s_nop 0
    buffer_load_dwordx4 v6, s[56:59], s38 offen lds
    s_waitcnt vmcnt(6)
    s_add_u32 s38, s39, 1179648
    s_add_u32 m0, s15, 18432
    s_nop 0
    buffer_load_dwordx4 v5, s[56:59], s38 offen lds
    s_add_u32 m0, s15, 19456
    s_nop 0
    buffer_load_dwordx4 v6, s[56:59], s38 offen lds
    s_waitcnt vmcnt(6)
    s_add_u32 s38, s39, 1245184
    s_add_u32 m0, s15, 20480
    s_nop 0
    buffer_load_dwordx4 v5, s[56:59], s38 offen lds
    s_add_u32 m0, s15, 21504
    s_nop 0
    buffer_load_dwordx4 v6, s[56:59], s38 offen lds
    s_waitcnt vmcnt(6)
    s_add_u32 s38, s39, 1310720
    s_add_u32 m0, s15, 22528
    s_nop 0
    buffer_load_dwordx4 v5, s[56:59], s38 offen lds
    s_add_u32 m0, s15, 23552
    s_nop 0
    buffer_load_dwordx4 v6, s[56:59], s38 offen lds
    s_waitcnt vmcnt(6)
    s_add_u32 s38, s39, 1376256
    s_add_u32 m0, s15, 24576
    s_nop 0
    buffer_load_dwordx4 v5, s[56:59], s38 offen lds
    s_add_u32 m0, s15, 25600
    s_nop 0
    buffer_load_dwordx4 v6, s[56:59], s38 offen lds
    s_waitcnt vmcnt(6)
    s_add_u32 s38, s39, 0
    s_add_u32 m0, s15, 26624
    s_nop 0
    buffer_load_dwordx4 v5, s[52:55], s38 offen lds
    s_add_u32 m0, s15, 27648
    s_nop 0
    buffer_load_dwordx4 v6, s[52:55], s38 offen lds
    s_waitcnt vmcnt(6)
    s_add_u32 s38, s39, 65536
    s_add_u32 m0, s15, 28672
    s_nop 0
    buffer_load_dwordx4 v5, s[52:55], s38 offen lds
    s_add_u32 m0, s15, 29696
    s_nop 0
    buffer_load_dwordx4 v6, s[52:55], s38 offen lds
    s_waitcnt vmcnt(6)
    s_add_u32 s38, s39, 131072
    s_add_u32 m0, s15, 30720
    s_nop 0
    buffer_load_dwordx4 v5, s[52:55], s38 offen lds
    s_add_u32 m0, s15, 31744
    s_nop 0
    buffer_load_dwordx4 v6, s[52:55], s38 offen lds
    s_waitcnt vmcnt(6)
    s_add_u32 s38, s39, 196608
    s_add_u32 m0, s15, 32768
    s_nop 0
    buffer_load_dwordx4 v5, s[52:55], s38 offen lds
    s_add_u32 m0, s15, 33792
    s_nop 0
    buffer_load_dwordx4 v6, s[52:55], s38 offen lds
    s_waitcnt vmcnt(6)
    s_add_u32 s38, s39, 262144
    s_add_u32 m0, s15, 34816
    s_nop 0
    buffer_load_dwordx4 v5, s[52:55], s38 offen lds
    s_add_u32 m0, s15, 35840
    s_nop 0
    buffer_load_dwordx4 v6, s[52:55], s38 offen lds
    s_waitcnt vmcnt(6)
    s_sub_u32 s14, s8, 4
    s_lshl_b32 s39, s14, 14
    s_add_u32 s38, s39, 327680
    buffer_load_dwordx4 v[80:83], v5, s[52:55], s38 offen
    buffer_load_dwordx4 v[84:87], v6, s[52:55], s38 offen
    s_waitcnt vmcnt(6)
    s_add_u32 s38, s39, 393216
    buffer_load_dwordx4 v[88:91], v5, s[52:55], s38 offen
    buffer_load_dwordx4 v[92:95], v6, s[52:55], s38 offen
    s_waitcnt vmcnt(6)
    s_add_u32 s38, s39, 458752
    buffer_load_dwordx4 v[96:99], v5, s[52:55], s38 offen
    buffer_load_dwordx4 v[100:103], v6, s[52:55], s38 offen
    s_waitcnt vmcnt(6)
    s_add_u32 s38, s39, 0
    buffer_load_dwordx4 v[104:107], v5, s[56:59], s38 offen
    buffer_load_dwordx4 v[108:111], v6, s[56:59], s38 offen
    s_waitcnt vmcnt(6)
    s_add_u32 s38, s39, 65536
    buffer_load_dwordx4 v[112:115], v5, s[56:59], s38 offen
    buffer_load_dwordx4 v[116:119], v6, s[56:59], s38 offen
    s_waitcnt vmcnt(6)
    s_add_u32 s38, s39, 131072
    buffer_load_dwordx4 v[120:123], v5, s[56:59], s38 offen
    buffer_load_dwordx4 v[124:127], v6, s[56:59], s38 offen
    s_waitcnt vmcnt(6)
    s_add_u32 s38, s39, 196608
    buffer_load_dwordx4 v[128:131], v5, s[56:59], s38 offen
    buffer_load_dwordx4 v[132:135], v6, s[56:59], s38 offen
    s_waitcnt vmcnt(6)
    s_add_u32 s38, s39, 262144
    buffer_load_dwordx4 v[136:139], v5, s[56:59], s38 offen
    buffer_load_dwordx4 v[140:143], v6, s[56:59], s38 offen
    s_waitcnt vmcnt(6)
    s_add_u32 s38, s39, 327680
    buffer_load_dwordx4 v[144:147], v5, s[56:59], s38 offen
    buffer_load_dwordx4 v[148:151], v6, s[56:59], s38 offen
    s_waitcnt vmcnt(6)
    s_add_u32 s38, s39, 393216
    buffer_load_dwordx4 v[152:155], v5, s[56:59], s38 offen
    buffer_load_dwordx4 v[156:159], v6, s[56:59], s38 offen
    s_waitcnt vmcnt(6)
    s_add_u32 s38, s39, 458752
    buffer_load_dwordx4 v[160:163], v5, s[56:59], s38 offen
    buffer_load_dwordx4 v[164:167], v6, s[56:59], s38 offen
    s_waitcnt vmcnt(6)
    s_add_u32 s38, s39, 524288
    buffer_load_dwordx4 v[168:171], v5, s[56:59], s38 offen
    buffer_load_dwordx4 v[172:175], v6, s[56:59], s38 offen
    s_waitcnt vmcnt(6)
    s_waitcnt vmcnt(0)
Lbdn_34:
    s_barrier
    s_barrier
    s_sub_u32 s14, s8, 4
    s_mul_i32 s15, s14, 36864
    v_lshlrev_b32 v8, 4, v0
    v_add_u32 v8, s15, v8
    ds_write_b128 v8, v[80:83] offset:0
    ds_write_b128 v8, v[84:87] offset:1024
    ds_write_b128 v8, v[88:91] offset:2048
    ds_write_b128 v8, v[92:95] offset:3072
    ds_write_b128 v8, v[96:99] offset:4096
    ds_write_b128 v8, v[100:103] offset:5120
    ds_write_b128 v8, v[104:107] offset:6144
    ds_write_b128 v8, v[108:111] offset:7168
    ds_write_b128 v8, v[112:115] offset:8192
    ds_write_b128 v8, v[116:119] offset:9216
    ds_write_b128 v8, v[120:123] offset:10240
    ds_write_b128 v8, v[124:127] offset:11264
    ds_write_b128 v8, v[128:131] offset:12288
    ds_write_b128 v8, v[132:135] offset:13312
    ds_write_b128 v8, v[136:139] offset:14336
    ds_write_b128 v8, v[140:143] offset:15360
    ds_write_b128 v8, v[144:147] offset:16384
    ds_write_b128 v8, v[148:151] offset:17408
    ds_write_b128 v8, v[152:155] offset:18432
    ds_write_b128 v8, v[156:159] offset:19456
    ds_write_b128 v8, v[160:163] offset:20480
    ds_write_b128 v8, v[164:167] offset:21504
    ds_write_b128 v8, v[168:171] offset:22528
    ds_write_b128 v8, v[172:175] offset:23552
    s_waitcnt lgkmcnt(0)
    s_barrier
    s_endpgm
L_cons:
    s_cmp_lg_u32 s8, 0
    s_cbranch_scc1 Ltlbw_35
    s_waitcnt lgkmcnt(0)
    s_lshl_b32 s13, s9, 17
    v_mov_b32 v30, s13
    global_load_dword v22, v30, s[16:17]
    s_cmp_eq_u32 s11, 0
    s_cselect_b32 s96, s18, s24
    s_cselect_b32 s97, s19, s25
    v_mov_b32 v30, 0
    global_load_dword v31, v30, s[96:97]
Ltlbw_35:
    s_cmp_eq_u32 s11, 0
    s_cbranch_scc0 L_cons_mlp
    s_barrier
    v_and_b32 v8, 15, v0
    v_lshrrev_b32 v9, 4, v0
    v_lshrrev_b32 v10, 1, v8
    v_xor_b32 v10, v9, v10
    v_lshlrev_b32 v11, 7, v8
    v_lshl_add_u32 v4, v10, 4, v11
    v_xor_b32 v5, 64, v4
    v_lshrrev_b32 v10, 2, v8
    v_lshl_add_u32 v10, v9, 3, v10
    v_lshrrev_b32 v11, 1, v10
    v_and_b32 v11, 1, v11
    v_lshrrev_b32 v12, 3, v10
    v_and_b32 v12, 1, v12
    v_lshl_add_u32 v11, v12, 1, v11
    v_lshlrev_b32 v11, 1, v11
    v_and_b32 v12, 3, v0
    v_lshrrev_b32 v12, 1, v12
    s_lshl_b32 s13, s8, 1
    v_add_u32 v12, s13, v12
    v_xor_b32 v12, v12, v11
    v_lshlrev_b32 v10, 7, v10
    v_lshl_add_u32 v10, v12, 4, v10
    v_and_b32 v12, 1, v0
    v_lshl_add_u32 v10, v12, 3, v10
    v_add_u32 v6, 18432, v10
    v_mov_b32 v232, 0
    v_mov_b32 v233, 0
    v_mov_b32 v234, 0
    v_mov_b32 v235, 0
    s_nop 1
    v_mfma_f32_32x32x16_bf16 v[128:143], v[232:235], v[232:235], 0
    v_mfma_f32_32x32x16_bf16 v[144:159], v[232:235], v[232:235], 0
    v_mfma_f32_32x32x16_bf16 v[160:175], v[232:235], v[232:235], 0
    v_mfma_f32_32x32x16_bf16 v[176:191], v[232:235], v[232:235], 0
    v_mfma_f32_32x32x16_bf16 v[192:207], v[232:235], v[232:235], 0
    v_mfma_f32_32x32x16_bf16 v[208:223], v[232:235], v[232:235], 0
    v_mfma_f32_32x32x16_bf16 v[224:239], v[232:235], v[232:235], 0
    v_and_b32 v8, 15, v0
    v_lshrrev_b32 v9, 4, v0
    v_lshl_add_u32 v10, v9, 2, 0
    v_sub_u32 v11, v8, v10
    v_and_b32 v11, 15, v11
    v_cmp_lt_u32 vcc, 7, v11
    v_mov_b32 v12, 0xf149f2ca
    s_nop 4
    v_cndmask_b32_e64 v232, 0, v12, vcc
    v_lshrrev_b32 v13, 3, v8
    v_lshrrev_b32 v14, 3, v10
    v_cmp_lt_u32 vcc, v13, v14
    s_nop 1
    v_cndmask_b32_e64 v236, v232, v12, vcc
    v_cmp_gt_u32 vcc, v13, v14
    s_nop 1
    v_cndmask_b32_e64 v240, v232, v12, vcc
    v_lshl_add_u32 v10, v9, 2, 1
    v_sub_u32 v11, v8, v10
    v_and_b32 v11, 15, v11
    v_cmp_lt_u32 vcc, 7, v11
    v_mov_b32 v12, 0xf149f2ca
    s_nop 0
    v_cndmask_b32_e64 v233, 0, v12, vcc
    v_lshrrev_b32 v13, 3, v8
    v_lshrrev_b32 v14, 3, v10
    v_cmp_lt_u32 vcc, v13, v14
    s_nop 1
    v_cndmask_b32_e64 v237, v233, v12, vcc
    v_cmp_gt_u32 vcc, v13, v14
    s_nop 1
    v_cndmask_b32_e64 v241, v233, v12, vcc
    v_lshl_add_u32 v10, v9, 2, 2
    v_sub_u32 v11, v8, v10
    v_and_b32 v11, 15, v11
    v_cmp_lt_u32 vcc, 7, v11
    v_mov_b32 v12, 0xf149f2ca
    s_nop 0
    v_cndmask_b32_e64 v234, 0, v12, vcc
    v_lshrrev_b32 v13, 3, v8
    v_lshrrev_b32 v14, 3, v10
    v_cmp_lt_u32 vcc, v13, v14
    s_nop 1
    v_cndmask_b32_e64 v238, v234, v12, vcc
    v_cmp_gt_u32 vcc, v13, v14
    s_nop 1
    v_cndmask_b32_e64 v242, v234, v12, vcc
    v_lshl_add_u32 v10, v9, 2, 3
    v_sub_u32 v11, v8, v10
    v_and_b32 v11, 15, v11
    v_cmp_lt_u32 vcc, 7, v11
    v_mov_b32 v12, 0xf149f2ca
    s_nop 0
    v_cndmask_b32_e64 v235, 0, v12, vcc
    v_lshrrev_b32 v13, 3, v8
    v_lshrrev_b32 v14, 3, v10
    v_cmp_lt_u32 vcc, v13, v14
    s_nop 1
    v_cndmask_b32_e64 v239, v235, v12, vcc
    v_cmp_gt_u32 vcc, v13, v14
    s_nop 1
    v_cndmask_b32_e64 v243, v235, v12, vcc
    s_cmp_eq_u32 s9, 0
    s_cbranch_scc1 Labz_36
    v_mov_b32 v236, v232
    v_mov_b32 v240, v232
    v_mov_b32 v237, v233
    v_mov_b32 v241, v233
    v_mov_b32 v238, v234
    v_mov_b32 v242, v234
    v_mov_b32 v239, v235
    v_mov_b32 v243, v235
Labz_36:
    v_cmp_gt_u32 s[68:69], 8, v8
    s_mov_b32 s70, -1
    s_mov_b32 s71, 0
    v_cndmask_b32_e64 v244, 0, -1, s[68:69]
    v_cndmask_b32_e64 v245, -1, 0, s[68:69]
    v_xor_b32 v246, 32, v0
    v_lshlrev_b32 v246, 2, v246
    s_waitcnt lgkmcnt(0)
    s_mov_b32 s40, s16
    s_and_b32 s41, s17, 0xffff
    s_mov_b32 s42, 2097152
    s_mov_b32 s43, 0x20000
    s_cmp_eq_u32 s11, 0
    s_cselect_b32 s44, s18, s24
    s_cselect_b32 s45, s19, s25
    s_mov_b32 s46, 1409024
    s_cselect_b32 s46, 1572864, s46
    s_and_b32 s45, s45, 0xffff
    s_mov_b32 s47, 0x20000
    s_add_u32 s64, s36, 8650752
    s_addc_u32 s65, s37, 0
    s_mov_b32 s60, 0
    v_mov_b32 v19, 0x3f803f80
    v_and_b32 v20, 15, v0
    s_lshl_b32 s13, s8, 4
    v_add_u32 v20, s13, v20
    v_lshrrev_b32 v21, 4, v0
    v_mul_u32_u24 v21, 192, v21
    v_add_u32 v20, v20, v21
    v_lshlrev_b32 v20, 2, v20
    v_add_u32 v20, 132096, v20
    s_barrier
    v_mov_b32 v1, v4
    v_mov_b32 v2, v5
    v_mov_b32 v3, v6
    ds_read_b64_tr_b16 v[68:69], v3 offset:0
    ds_read_b64_tr_b16 v[70:71], v3 offset:512
    ds_read_b64_tr_b16 v[72:73], v3 offset:8192
    ds_read_b64_tr_b16 v[74:75], v3 offset:8704
    ds_read_b64_tr_b16 v[76:77], v3 offset:16384
    ds_read_b64_tr_b16 v[78:79], v3 offset:16896
    ds_read_b128 v[32:35], v1 offset:0
    ds_read_b128 v[36:39], v1 offset:2048
    ds_read_b128 v[40:43], v1 offset:4096
    ds_read_b128 v[44:47], v1 offset:6144
    ds_read_b128 v[48:51], v1 offset:8192
    ds_read_b128 v[52:55], v1 offset:10240
    ds_read_b128 v[56:59], v1 offset:12288
    ds_read_b128 v[60:63], v1 offset:14336
    ds_read_b128 v[64:67], v1 offset:16384
    s_waitcnt lgkmcnt(0)
    v_mfma_f32_16x16x32_bf16 v[160:163], v[72:75], v[32:35], v[160:163]
    ds_read_b64_tr_b16 v[116:117], v3 offset:4096
    v_mfma_f32_16x16x32_bf16 v[196:199], v[32:35], v[76:79], v[196:199]
    ds_read_b64_tr_b16 v[118:119], v3 offset:4608
    v_mfma_f32_16x16x32_bf16 v[164:167], v[72:75], v[36:39], v[164:167]
    ds_read_b64_tr_b16 v[120:121], v3 offset:12288
    v_mfma_f32_16x16x32_bf16 v[200:203], v[36:39], v[76:79], v[200:203]
    ds_read_b64_tr_b16 v[122:123], v3 offset:12800
    v_mfma_f32_16x16x32_bf16 v[128:131], v[68:71], v[36:39], v[128:131]
    ds_read_b64_tr_b16 v[124:125], v3 offset:20480
    v_mfma_f32_16x16x32_bf16 v[168:171], v[72:75], v[40:43], v[168:171]
    ds_read_b64_tr_b16 v[126:127], v3 offset:20992
    v_mfma_f32_16x16x32_bf16 v[204:207], v[40:43], v[76:79], v[204:207]
    ds_read_b128 v[80:83], v2 offset:0
    v_mfma_f32_16x16x32_bf16 v[132:135], v[68:71], v[40:43], v[132:135]
    ds_read_b128 v[84:87], v2 offset:2048
    v_mfma_f32_16x16x32_bf16 v[172:175], v[72:75], v[44:47], v[172:175]
    ds_read_b128 v[88:91], v2 offset:4096
    v_mfma_f32_16x16x32_bf16 v[208:211], v[44:47], v[76:79], v[208:211]
    ds_read_b128 v[92:95], v2 offset:6144
    v_mfma_f32_16x16x32_bf16 v[136:139], v[68:71], v[44:47], v[136:139]
    ds_read_b128 v[96:99], v2 offset:8192
    v_mfma_f32_16x16x32_bf16 v[176:179], v[72:75], v[48:51], v[176:179]
    ds_read_b128 v[100:103], v2 offset:10240
    v_mfma_f32_16x16x32_bf16 v[212:215], v[48:51], v[76:79], v[212:215]
    ds_read_b128 v[104:107], v2 offset:12288
    v_mfma_f32_16x16x32_bf16 v[140:143], v[68:71], v[48:51], v[140:143]
    ds_read_b128 v[108:111], v2 offset:14336
    v_mfma_f32_16x16x32_bf16 v[180:183], v[72:75], v[52:55], v[180:183]
    ds_read_b128 v[112:115], v2 offset:16384
    v_mfma_f32_16x16x32_bf16 v[216:219], v[52:55], v[76:79], v[216:219]
    v_mfma_f32_16x16x32_bf16 v[144:147], v[68:71], v[52:55], v[144:147]
    v_mfma_f32_16x16x32_bf16 v[184:187], v[72:75], v[56:59], v[184:187]
    v_mfma_f32_16x16x32_bf16 v[220:223], v[56:59], v[76:79], v[220:223]
    v_mfma_f32_16x16x32_bf16 v[148:151], v[68:71], v[56:59], v[148:151]
    v_mfma_f32_16x16x32_bf16 v[188:191], v[72:75], v[60:63], v[188:191]
    v_mfma_f32_16x16x32_bf16 v[224:227], v[60:63], v[76:79], v[224:227]
    v_mfma_f32_16x16x32_bf16 v[152:155], v[68:71], v[60:63], v[152:155]
    v_mfma_f32_16x16x32_bf16 v[192:195], v[72:75], v[64:67], v[192:195]
    v_mfma_f32_16x16x32_bf16 v[228:231], v[64:67], v[76:79], v[228:231]
    v_mfma_f32_16x16x32_bf16 v[156:159], v[68:71], v[64:67], v[156:159]
    s_and_b32 s13, s78, 1
    s_cbranch_scc0 Lacs_37
    v_dot2_f32_bf16 v16, v68, v19, 0
    v_dot2_f32_bf16 v16, v69, v19, v16
    v_dot2_f32_bf16 v16, v70, v19, v16
    v_dot2_f32_bf16 v16, v71, v19, v16
    v_dot2_f32_bf16 v17, v72, v19, 0
    v_dot2_f32_bf16 v17, v73, v19, v17
    v_dot2_f32_bf16 v17, v74, v19, v17
    v_dot2_f32_bf16 v17, v75, v19, v17
    v_dot2_f32_bf16 v18, v76, v19, 0
    v_dot2_f32_bf16 v18, v77, v19, v18
    v_dot2_f32_bf16 v18, v78, v19, v18
    v_dot2_f32_bf16 v18, v79, v19, v18
Lacs_37:
    s_waitcnt lgkmcnt(0)
    v_mfma_f32_16x16x32_bf16 v[160:163], v[120:123], v[80:83], v[160:163]
    v_mfma_f32_16x16x32_bf16 v[196:199], v[80:83], v[124:127], v[196:199]
    s_barrier
    v_mfma_f32_16x16x32_bf16 v[164:167], v[120:123], v[84:87], v[164:167]
    s_add_u32 s60, s60, 43008
    s_cmp_eq_u32 s60, 129024
    s_cselect_b32 s60, 0, s60
    v_mfma_f32_16x16x32_bf16 v[200:203], v[84:87], v[124:127], v[200:203]
    v_add_u32 v3, s60, v6
    v_add_u32 v1, s60, v4
    v_mfma_f32_16x16x32_bf16 v[128:131], v[116:119], v[84:87], v[128:131]
    v_add_u32 v2, s60, v5
    v_mfma_f32_16x16x32_bf16 v[168:171], v[120:123], v[88:91], v[168:171]
    ds_read_b64_tr_b16 v[68:69], v3 offset:0
    v_mfma_f32_16x16x32_bf16 v[204:207], v[88:91], v[124:127], v[204:207]
    ds_read_b64_tr_b16 v[70:71], v3 offset:512
    v_mfma_f32_16x16x32_bf16 v[132:135], v[116:119], v[88:91], v[132:135]
    ds_read_b64_tr_b16 v[72:73], v3 offset:8192
    v_mfma_f32_16x16x32_bf16 v[172:175], v[120:123], v[92:95], v[172:175]
    ds_read_b64_tr_b16 v[74:75], v3 offset:8704
    v_mfma_f32_16x16x32_bf16 v[208:211], v[92:95], v[124:127], v[208:211]
    ds_read_b64_tr_b16 v[76:77], v3 offset:16384
    v_mfma_f32_16x16x32_bf16 v[136:139], v[116:119], v[92:95], v[136:139]
    ds_read_b64_tr_b16 v[78:79], v3 offset:16896
    v_mfma_f32_16x16x32_bf16 v[176:179], v[120:123], v[96:99], v[176:179]
    ds_read_b128 v[32:35], v1 offset:0
    v_mfma_f32_16x16x32_bf16 v[212:215], v[96:99], v[124:127], v[212:215]
    ds_read_b128 v[36:39], v1 offset:2048
    v_mfma_f32_16x16x32_bf16 v[140:143], v[116:119], v[96:99], v[140:143]
    ds_read_b128 v[40:43], v1 offset:4096
    v_mfma_f32_16x16x32_bf16 v[180:183], v[120:123], v[100:103], v[180:183]
    ds_read_b128 v[44:47], v1 offset:6144
    v_mfma_f32_16x16x32_bf16 v[216:219], v[100:103], v[124:127], v[216:219]
    ds_read_b128 v[48:51], v1 offset:8192
    v_mfma_f32_16x16x32_bf16 v[144:147], v[116:119], v[100:103], v[144:147]
    ds_read_b128 v[52:55], v1 offset:10240
    v_mfma_f32_16x16x32_bf16 v[184:187], v[120:123], v[104:107], v[184:187]
    ds_read_b128 v[56:59], v1 offset:12288
    v_mfma_f32_16x16x32_bf16 v[220:223], v[104:107], v[124:127], v[220:223]
    ds_read_b128 v[60:63], v1 offset:14336
    v_mfma_f32_16x16x32_bf16 v[148:151], v[116:119], v[104:107], v[148:151]
    ds_read_b128 v[64:67], v1 offset:16384
    v_mfma_f32_16x16x32_bf16 v[188:191], v[120:123], v[108:111], v[188:191]
    v_mfma_f32_16x16x32_bf16 v[224:227], v[108:111], v[124:127], v[224:227]
    v_mfma_f32_16x16x32_bf16 v[152:155], v[116:119], v[108:111], v[152:155]
    v_mfma_f32_16x16x32_bf16 v[192:195], v[120:123], v[112:115], v[192:195]
    v_mfma_f32_16x16x32_bf16 v[228:231], v[112:115], v[124:127], v[228:231]
    v_mfma_f32_16x16x32_bf16 v[156:159], v[116:119], v[112:115], v[156:159]
    s_and_b32 s13, s78, 1
    s_cbranch_scc0 Lacs_38
    v_dot2_f32_bf16 v16, v116, v19, v16
    v_dot2_f32_bf16 v16, v117, v19, v16
    v_dot2_f32_bf16 v16, v118, v19, v16
    v_dot2_f32_bf16 v16, v119, v19, v16
    v_dot2_f32_bf16 v17, v120, v19, v17
    v_dot2_f32_bf16 v17, v121, v19, v17
    v_dot2_f32_bf16 v17, v122, v19, v17
    v_dot2_f32_bf16 v17, v123, v19, v17
    v_dot2_f32_bf16 v18, v124, v19, v18
    v_dot2_f32_bf16 v18, v125, v19, v18
    v_dot2_f32_bf16 v18, v126, v19, v18
    v_dot2_f32_bf16 v18, v127, v19, v18
Lacs_38:
    s_waitcnt lgkmcnt(0)
    v_mfma_f32_16x16x32_bf16 v[160:163], v[72:75], v[32:35], v[160:163]
    ds_read_b64_tr_b16 v[116:117], v3 offset:4096
    v_mfma_f32_16x16x32_bf16 v[196:199], v[32:35], v[76:79], v[196:199]
    ds_read_b64_tr_b16 v[118:119], v3 offset:4608
    v_mfma_f32_16x16x32_bf16 v[164:167], v[72:75], v[36:39], v[164:167]
    ds_read_b64_tr_b16 v[120:121], v3 offset:12288
    v_mfma_f32_16x16x32_bf16 v[200:203], v[36:39], v[76:79], v[200:203]
    ds_read_b64_tr_b16 v[122:123], v3 offset:12800
    v_mfma_f32_16x16x32_bf16 v[128:131], v[68:71], v[36:39], v[128:131]
    ds_read_b64_tr_b16 v[124:125], v3 offset:20480
    v_mfma_f32_16x16x32_bf16 v[168:171], v[72:75], v[40:43], v[168:171]
    ds_read_b64_tr_b16 v[126:127], v3 offset:20992
    v_mfma_f32_16x16x32_bf16 v[204:207], v[40:43], v[76:79], v[204:207]
    ds_read_b128 v[80:83], v2 offset:0
    v_mfma_f32_16x16x32_bf16 v[132:135], v[68:71], v[40:43], v[132:135]
    ds_read_b128 v[84:87], v2 offset:2048
    v_mfma_f32_16x16x32_bf16 v[172:175], v[72:75], v[44:47], v[172:175]
    ds_read_b128 v[88:91], v2 offset:4096
    v_mfma_f32_16x16x32_bf16 v[208:211], v[44:47], v[76:79], v[208:211]
    ds_read_b128 v[92:95], v2 offset:6144
    v_mfma_f32_16x16x32_bf16 v[136:139], v[68:71], v[44:47], v[136:139]
    ds_read_b128 v[96:99], v2 offset:8192
    v_mfma_f32_16x16x32_bf16 v[176:179], v[72:75], v[48:51], v[176:179]
    ds_read_b128 v[100:103], v2 offset:10240
    v_mfma_f32_16x16x32_bf16 v[212:215], v[48:51], v[76:79], v[212:215]
    ds_read_b128 v[104:107], v2 offset:12288
    v_mfma_f32_16x16x32_bf16 v[140:143], v[68:71], v[48:51], v[140:143]
    ds_read_b128 v[108:111], v2 offset:14336
    v_mfma_f32_16x16x32_bf16 v[180:183], v[72:75], v[52:55], v[180:183]
    ds_read_b128 v[112:115], v2 offset:16384
    v_mfma_f32_16x16x32_bf16 v[216:219], v[52:55], v[76:79], v[216:219]
    v_mfma_f32_16x16x32_bf16 v[144:147], v[68:71], v[52:55], v[144:147]
    v_mfma_f32_16x16x32_bf16 v[184:187], v[72:75], v[56:59], v[184:187]
    v_mfma_f32_16x16x32_bf16 v[220:223], v[56:59], v[76:79], v[220:223]
    v_mfma_f32_16x16x32_bf16 v[148:151], v[68:71], v[56:59], v[148:151]
    v_mfma_f32_16x16x32_bf16 v[188:191], v[72:75], v[60:63], v[188:191]
    v_mfma_f32_16x16x32_bf16 v[224:227], v[60:63], v[76:79], v[224:227]
    v_mfma_f32_16x16x32_bf16 v[152:155], v[68:71], v[60:63], v[152:155]
    v_mfma_f32_16x16x32_bf16 v[192:195], v[72:75], v[64:67], v[192:195]
    v_mfma_f32_16x16x32_bf16 v[228:231], v[64:67], v[76:79], v[228:231]
    v_mfma_f32_16x16x32_bf16 v[156:159], v[68:71], v[64:67], v[156:159]
    s_and_b32 s13, s78, 1
    s_cbranch_scc0 Lacs_39
    v_dot2_f32_bf16 v16, v68, v19, v16
    v_dot2_f32_bf16 v16, v69, v19, v16
    v_dot2_f32_bf16 v16, v70, v19, v16
    v_dot2_f32_bf16 v16, v71, v19, v16
    v_dot2_f32_bf16 v17, v72, v19, v17
    v_dot2_f32_bf16 v17, v73, v19, v17
    v_dot2_f32_bf16 v17, v74, v19, v17
    v_dot2_f32_bf16 v17, v75, v19, v17
    v_dot2_f32_bf16 v18, v76, v19, v18
    v_dot2_f32_bf16 v18, v77, v19, v18
    v_dot2_f32_bf16 v18, v78, v19, v18
    v_dot2_f32_bf16 v18, v79, v19, v18
Lacs_39:
    s_waitcnt lgkmcnt(0)
    v_mfma_f32_16x16x32_bf16 v[160:163], v[120:123], v[80:83], v[160:163]
    v_mfma_f32_16x16x32_bf16 v[196:199], v[80:83], v[124:127], v[196:199]
    s_barrier
    v_mfma_f32_16x16x32_bf16 v[164:167], v[120:123], v[84:87], v[164:167]
    s_add_u32 s60, s60, 43008
    s_cmp_eq_u32 s60, 129024
    s_cselect_b32 s60, 0, s60
    v_mfma_f32_16x16x32_bf16 v[200:203], v[84:87], v[124:127], v[200:203]
    v_add_u32 v3, s60, v6
    v_add_u32 v1, s60, v4
    v_mfma_f32_16x16x32_bf16 v[128:131], v[116:119], v[84:87], v[128:131]
    v_add_u32 v2, s60, v5
    v_mfma_f32_16x16x32_bf16 v[168:171], v[120:123], v[88:91], v[168:171]
    ds_read_b64_tr_b16 v[68:69], v3 offset:0
    v_mfma_f32_16x16x32_bf16 v[204:207], v[88:91], v[124:127], v[204:207]
    ds_read_b64_tr_b16 v[70:71], v3 offset:512
    v_mfma_f32_16x16x32_bf16 v[132:135], v[116:119], v[88:91], v[132:135]
    ds_read_b64_tr_b16 v[72:73], v3 offset:8192
    v_mfma_f32_16x16x32_bf16 v[172:175], v[120:123], v[92:95], v[172:175]
    ds_read_b64_tr_b16 v[74:75], v3 offset:8704
    v_mfma_f32_16x16x32_bf16 v[208:211], v[92:95], v[124:127], v[208:211]
    ds_read_b64_tr_b16 v[76:77], v3 offset:16384
    v_mfma_f32_16x16x32_bf16 v[136:139], v[116:119], v[92:95], v[136:139]
    ds_read_b64_tr_b16 v[78:79], v3 offset:16896
    v_mfma_f32_16x16x32_bf16 v[176:179], v[120:123], v[96:99], v[176:179]
    ds_read_b128 v[32:35], v1 offset:0
    v_mfma_f32_16x16x32_bf16 v[212:215], v[96:99], v[124:127], v[212:215]
    ds_read_b128 v[36:39], v1 offset:2048
    v_mfma_f32_16x16x32_bf16 v[140:143], v[116:119], v[96:99], v[140:143]
    ds_read_b128 v[40:43], v1 offset:4096
    v_mfma_f32_16x16x32_bf16 v[180:183], v[120:123], v[100:103], v[180:183]
    ds_read_b128 v[44:47], v1 offset:6144
    v_mfma_f32_16x16x32_bf16 v[216:219], v[100:103], v[124:127], v[216:219]
    ds_read_b128 v[48:51], v1 offset:8192
    v_mfma_f32_16x16x32_bf16 v[144:147], v[116:119], v[100:103], v[144:147]
    ds_read_b128 v[52:55], v1 offset:10240
    v_mfma_f32_16x16x32_bf16 v[184:187], v[120:123], v[104:107], v[184:187]
    ds_read_b128 v[56:59], v1 offset:12288
    v_mfma_f32_16x16x32_bf16 v[220:223], v[104:107], v[124:127], v[220:223]
    ds_read_b128 v[60:63], v1 offset:14336
    v_mfma_f32_16x16x32_bf16 v[148:151], v[116:119], v[104:107], v[148:151]
    ds_read_b128 v[64:67], v1 offset:16384
    v_mfma_f32_16x16x32_bf16 v[188:191], v[120:123], v[108:111], v[188:191]
    v_mfma_f32_16x16x32_bf16 v[224:227], v[108:111], v[124:127], v[224:227]
    v_mfma_f32_16x16x32_bf16 v[152:155], v[116:119], v[108:111], v[152:155]
    v_mfma_f32_16x16x32_bf16 v[192:195], v[120:123], v[112:115], v[192:195]
    v_mfma_f32_16x16x32_bf16 v[228:231], v[112:115], v[124:127], v[228:231]
    v_mfma_f32_16x16x32_bf16 v[156:159], v[116:119], v[112:115], v[156:159]
    s_and_b32 s13, s78, 1
    s_cbranch_scc0 Lacs_40
    v_dot2_f32_bf16 v16, v116, v19, v16
    v_dot2_f32_bf16 v16, v117, v19, v16
    v_dot2_f32_bf16 v16, v118, v19, v16
    v_dot2_f32_bf16 v16, v119, v19, v16
    v_dot2_f32_bf16 v17, v120, v19, v17
    v_dot2_f32_bf16 v17, v121, v19, v17
    v_dot2_f32_bf16 v17, v122, v19, v17
    v_dot2_f32_bf16 v17, v123, v19, v17
    v_dot2_f32_bf16 v18, v124, v19, v18
    v_dot2_f32_bf16 v18, v125, v19, v18
    v_dot2_f32_bf16 v18, v126, v19, v18
    v_dot2_f32_bf16 v18, v127, v19, v18
    s_nop 2
    ds_write_b32 v20, v16 offset:0
    ds_write_b32 v20, v17 offset:256
    ds_write_b32 v20, v18 offset:512
    s_lshl_b32 s13, s8, 2
    s_add_u32 s13, s13, 163680
    v_mov_b32 v8, s13
    v_mov_b32 v9, 1
    ds_write_b32 v8, v9
Lacs_40:
    s_mov_b32 s63, 6
.p2align 6
Laloop_41:
    s_waitcnt lgkmcnt(0)
    v_mfma_f32_16x16x32_bf16 v[160:163], v[72:75], v[32:35], v[160:163]
    ds_read_b64_tr_b16 v[116:117], v3 offset:4096
    v_mfma_f32_16x16x32_bf16 v[196:199], v[32:35], v[76:79], v[196:199]
    ds_read_b64_tr_b16 v[118:119], v3 offset:4608
    v_mfma_f32_16x16x32_bf16 v[164:167], v[72:75], v[36:39], v[164:167]
    ds_read_b64_tr_b16 v[120:121], v3 offset:12288
    v_mfma_f32_16x16x32_bf16 v[200:203], v[36:39], v[76:79], v[200:203]
    ds_read_b64_tr_b16 v[122:123], v3 offset:12800
    v_mfma_f32_16x16x32_bf16 v[128:131], v[68:71], v[36:39], v[128:131]
    ds_read_b64_tr_b16 v[124:125], v3 offset:20480
    v_mfma_f32_16x16x32_bf16 v[168:171], v[72:75], v[40:43], v[168:171]
    ds_read_b64_tr_b16 v[126:127], v3 offset:20992
    v_mfma_f32_16x16x32_bf16 v[204:207], v[40:43], v[76:79], v[204:207]
    ds_read_b128 v[80:83], v2 offset:0
    v_mfma_f32_16x16x32_bf16 v[132:135], v[68:71], v[40:43], v[132:135]
    ds_read_b128 v[84:87], v2 offset:2048
    v_mfma_f32_16x16x32_bf16 v[172:175], v[72:75], v[44:47], v[172:175]
    ds_read_b128 v[88:91], v2 offset:4096
    v_mfma_f32_16x16x32_bf16 v[208:211], v[44:47], v[76:79], v[208:211]
    ds_read_b128 v[92:95], v2 offset:6144
    v_mfma_f32_16x16x32_bf16 v[136:139], v[68:71], v[44:47], v[136:139]
    ds_read_b128 v[96:99], v2 offset:8192
    v_mfma_f32_16x16x32_bf16 v[176:179], v[72:75], v[48:51], v[176:179]
    ds_read_b128 v[100:103], v2 offset:10240
    v_mfma_f32_16x16x32_bf16 v[212:215], v[48:51], v[76:79], v[212:215]
    ds_read_b128 v[104:107], v2 offset:12288
    v_mfma_f32_16x16x32_bf16 v[140:143], v[68:71], v[48:51], v[140:143]
    ds_read_b128 v[108:111], v2 offset:14336
    v_mfma_f32_16x16x32_bf16 v[180:183], v[72:75], v[52:55], v[180:183]
    ds_read_b128 v[112:115], v2 offset:16384
    v_mfma_f32_16x16x32_bf16 v[216:219], v[52:55], v[76:79], v[216:219]
    v_mfma_f32_16x16x32_bf16 v[144:147], v[68:71], v[52:55], v[144:147]
    v_mfma_f32_16x16x32_bf16 v[184:187], v[72:75], v[56:59], v[184:187]
    v_mfma_f32_16x16x32_bf16 v[220:223], v[56:59], v[76:79], v[220:223]
    v_mfma_f32_16x16x32_bf16 v[148:151], v[68:71], v[56:59], v[148:151]
    v_mfma_f32_16x16x32_bf16 v[188:191], v[72:75], v[60:63], v[188:191]
    v_mfma_f32_16x16x32_bf16 v[224:227], v[60:63], v[76:79], v[224:227]
    v_mfma_f32_16x16x32_bf16 v[152:155], v[68:71], v[60:63], v[152:155]
    v_mfma_f32_16x16x32_bf16 v[192:195], v[72:75], v[64:67], v[192:195]
    v_mfma_f32_16x16x32_bf16 v[228:231], v[64:67], v[76:79], v[228:231]
    v_mfma_f32_16x16x32_bf16 v[156:159], v[68:71], v[64:67], v[156:159]
    s_waitcnt lgkmcnt(0)
    v_mfma_f32_16x16x32_bf16 v[160:163], v[120:123], v[80:83], v[160:163]
    v_mfma_f32_16x16x32_bf16 v[196:199], v[80:83], v[124:127], v[196:199]
    s_barrier
    v_mfma_f32_16x16x32_bf16 v[164:167], v[120:123], v[84:87], v[164:167]
    s_add_u32 s60, s60, 43008
    s_cmp_eq_u32 s60, 129024
    s_cselect_b32 s60, 0, s60
    v_mfma_f32_16x16x32_bf16 v[200:203], v[84:87], v[124:127], v[200:203]
    v_add_u32 v3, s60, v6
    v_add_u32 v1, s60, v4
    v_mfma_f32_16x16x32_bf16 v[128:131], v[116:119], v[84:87], v[128:131]
    v_add_u32 v2, s60, v5
    v_mfma_f32_16x16x32_bf16 v[168:171], v[120:123], v[88:91], v[168:171]
    ds_read_b64_tr_b16 v[68:69], v3 offset:0
    v_mfma_f32_16x16x32_bf16 v[204:207], v[88:91], v[124:127], v[204:207]
    ds_read_b64_tr_b16 v[70:71], v3 offset:512
    v_mfma_f32_16x16x32_bf16 v[132:135], v[116:119], v[88:91], v[132:135]
    ds_read_b64_tr_b16 v[72:73], v3 offset:8192
    v_mfma_f32_16x16x32_bf16 v[172:175], v[120:123], v[92:95], v[172:175]
    ds_read_b64_tr_b16 v[74:75], v3 offset:8704
    v_mfma_f32_16x16x32_bf16 v[208:211], v[92:95], v[124:127], v[208:211]
    ds_read_b64_tr_b16 v[76:77], v3 offset:16384
    v_mfma_f32_16x16x32_bf16 v[136:139], v[116:119], v[92:95], v[136:139]
    ds_read_b64_tr_b16 v[78:79], v3 offset:16896
    v_mfma_f32_16x16x32_bf16 v[176:179], v[120:123], v[96:99], v[176:179]
    ds_read_b128 v[32:35], v1 offset:0
    v_mfma_f32_16x16x32_bf16 v[212:215], v[96:99], v[124:127], v[212:215]
    ds_read_b128 v[36:39], v1 offset:2048
    v_mfma_f32_16x16x32_bf16 v[140:143], v[116:119], v[96:99], v[140:143]
    ds_read_b128 v[40:43], v1 offset:4096
    v_mfma_f32_16x16x32_bf16 v[180:183], v[120:123], v[100:103], v[180:183]
    ds_read_b128 v[44:47], v1 offset:6144
    v_mfma_f32_16x16x32_bf16 v[216:219], v[100:103], v[124:127], v[216:219]
    ds_read_b128 v[48:51], v1 offset:8192
    v_mfma_f32_16x16x32_bf16 v[144:147], v[116:119], v[100:103], v[144:147]
    ds_read_b128 v[52:55], v1 offset:10240
    v_mfma_f32_16x16x32_bf16 v[184:187], v[120:123], v[104:107], v[184:187]
    ds_read_b128 v[56:59], v1 offset:12288
    v_mfma_f32_16x16x32_bf16 v[220:223], v[104:107], v[124:127], v[220:223]
    ds_read_b128 v[60:63], v1 offset:14336
    v_mfma_f32_16x16x32_bf16 v[148:151], v[116:119], v[104:107], v[148:151]
    ds_read_b128 v[64:67], v1 offset:16384
    v_mfma_f32_16x16x32_bf16 v[188:191], v[120:123], v[108:111], v[188:191]
    v_mfma_f32_16x16x32_bf16 v[224:227], v[108:111], v[124:127], v[224:227]
    v_mfma_f32_16x16x32_bf16 v[152:155], v[116:119], v[108:111], v[152:155]
    v_mfma_f32_16x16x32_bf16 v[192:195], v[120:123], v[112:115], v[192:195]
    v_mfma_f32_16x16x32_bf16 v[228:231], v[112:115], v[124:127], v[228:231]
    v_mfma_f32_16x16x32_bf16 v[156:159], v[116:119], v[112:115], v[156:159]
    s_sub_u32 s63, s63, 1
    s_cmp_lg_u32 s63, 0
    s_cbranch_scc1 Laloop_41
    s_waitcnt lgkmcnt(0)
    s_waitcnt vmcnt(0)
    v_mov_b32 v14, 163648
    s_mov_b32 s95, 0
Lwst_42:
    ds_read_b32 v15, v14
    ds_read_b32 v8, v14 offset:4
    ds_read_b32 v9, v14 offset:8
    s_waitcnt lgkmcnt(0)
    v_add3_u32 v15, v15, v8, v9
    s_nop 0
    v_readfirstlane_b32 s94, v15
    s_nop 0
    s_cmp_eq_u32 s94, 3
    s_cbranch_scc1 Lwsd_43
    s_add_u32 s95, s95, 1
    s_cmp_gt_u32 s95, 8388608
    s_cbranch_scc1 Lwsd_43
    s_sleep 1
    s_branch Lwst_42
Lwsd_43:
    v_and_b32 v8, 15, v0
    v_lshrrev_b32 v9, 4, v0
    v_lshlrev_b32 v10, 3, v8
    v_add_u32 v10, 155648, v10
    v_lshlrev_b32 v11, 4, v9
    v_add_u32 v11, 156800, v11
    s_lshl_b32 s13, s8, 6
    v_lshl_add_u32 v12, v9, 4, s13
    v_add_u32 v12, 157952, v12
    v_lshl_add_u32 v13, v8, 2, s13
    v_add_u32 v13, 157952, v13
    ds_read_b128 v[16:19], v12
    ds_read_b128 v[20:23], v12 offset:256
    ds_read_b32 v24, v13 offset:512
    v_mov_b32 v28, 0x3f803f80
    v_mov_b32 v29, 0x3f803f80
    v_mov_b32 v30, 0x3f803f80
    v_mov_b32 v31, 0x3f803f80
    s_mov_b32 s72, 0x3eb8aa3b
    s_mov_b32 s73, 0x3eb8aa3b
    ds_read_b64 v[116:117], v10 offset:0
    ds_read_b64 v[120:121], v10 offset:128
    ds_read_b64 v[124:125], v10 offset:256
    s_waitcnt lgkmcnt(2)
    v_pk_mul_f32 v[118:119], v[20:21], v[116:117] op_sel:[0,1] op_sel_hi:[1,1]
    s_waitcnt lgkmcnt(1)
    v_pk_mul_f32 v[122:123], v[20:21], v[120:121] op_sel:[0,1] op_sel_hi:[1,1]
    s_waitcnt lgkmcnt(0)
    v_pk_mul_f32 v[126:127], v[20:21], v[124:125] op_sel:[0,1] op_sel_hi:[1,1]
    v_pk_fma_f32 v[160:161], v[160:161], v[116:117], v[118:119] op_sel_hi:[1,0,1] neg_lo:[0,0,1] neg_hi:[0,0,1]
    v_pk_fma_f32 v[164:165], v[164:165], v[120:121], v[122:123] op_sel_hi:[1,0,1] neg_lo:[0,0,1] neg_hi:[0,0,1]
    v_pk_fma_f32 v[168:169], v[168:169], v[124:125], v[126:127] op_sel_hi:[1,0,1] neg_lo:[0,0,1] neg_hi:[0,0,1]
    v_pk_mul_f32 v[118:119], v[22:23], v[116:117] op_sel:[0,1] op_sel_hi:[1,1]
    v_pk_mul_f32 v[122:123], v[22:23], v[120:121] op_sel:[0,1] op_sel_hi:[1,1]
    v_pk_mul_f32 v[126:127], v[22:23], v[124:125] op_sel:[0,1] op_sel_hi:[1,1]
    v_pk_fma_f32 v[162:163], v[162:163], v[116:117], v[118:119] op_sel_hi:[1,0,1] neg_lo:[0,0,1] neg_hi:[0,0,1]
    v_pk_fma_f32 v[166:167], v[166:167], v[120:121], v[122:123] op_sel_hi:[1,0,1] neg_lo:[0,0,1] neg_hi:[0,0,1]
    v_pk_fma_f32 v[170:171], v[170:171], v[124:125], v[126:127] op_sel_hi:[1,0,1] neg_lo:[0,0,1] neg_hi:[0,0,1]
    v_cvt_pk_bf16_f32 v96, v160, v161
    v_cvt_pk_bf16_f32 v34, v164, v165
    v_cvt_pk_bf16_f32 v38, v168, v169
    v_cvt_pk_bf16_f32 v97, v162, v163
    v_cvt_pk_bf16_f32 v35, v166, v167
    v_cvt_pk_bf16_f32 v39, v170, v171
    ds_read_b128 v[160:163], v11 offset:0
    v_pk_mul_f32 v[122:123], v[16:17], v[120:121] op_sel:[0,1] op_sel_hi:[1,1]
    v_pk_mul_f32 v[126:127], v[16:17], v[124:125] op_sel:[0,1] op_sel_hi:[1,1]
    ds_read_b128 v[248:251], v11 offset:576
    v_pk_fma_f32 v[128:129], v[128:129], v[120:121], v[122:123] op_sel_hi:[1,0,1] neg_lo:[0,0,1] neg_hi:[0,0,1]
    v_pk_fma_f32 v[132:133], v[132:133], v[124:125], v[126:127] op_sel_hi:[1,0,1] neg_lo:[0,0,1] neg_hi:[0,0,1]
    v_pk_mul_f32 v[122:123], v[18:19], v[120:121] op_sel:[0,1] op_sel_hi:[1,1]
    v_pk_mul_f32 v[126:127], v[18:19], v[124:125] op_sel:[0,1] op_sel_hi:[1,1]
    v_pk_fma_f32 v[130:131], v[130:131], v[120:121], v[122:123] op_sel_hi:[1,0,1] neg_lo:[0,0,1] neg_hi:[0,0,1]
    v_cvt_pk_bf16_f32 v100, v128, v129
    v_cvt_pk_bf16_f32 v101, v130, v131
    v_pk_fma_f32 v[134:135], v[134:135], v[124:125], v[126:127] op_sel_hi:[1,0,1] neg_lo:[0,0,1] neg_hi:[0,0,1]
    ds_read_b128 v[164:167], v11 offset:64
    ds_read_b128 v[128:131], v11 offset:640
    v_cvt_pk_bf16_f32 v102, v132, v133
    v_cvt_pk_bf16_f32 v103, v134, v135
    ds_read_b128 v[168:171], v11 offset:128
    ds_read_b128 v[132:135], v11 offset:704
    s_waitcnt lgkmcnt(4)
    v_pk_mul_f32 v[248:249], v[248:249], v[24:25] op_sel_hi:[1,0]
    v_pk_fma_f32 v[196:197], v[196:197], v[160:161], v[248:249] neg_lo:[0,0,1] neg_hi:[0,0,1]
    v_pk_mul_f32 v[250:251], v[250:251], v[24:25] op_sel_hi:[1,0]
    v_pk_fma_f32 v[198:199], v[198:199], v[162:163], v[250:251] neg_lo:[0,0,1] neg_hi:[0,0,1]
    v_cvt_pk_bf16_f32 v98, v196, v197
    v_cvt_pk_bf16_f32 v99, v198, v199
    ds_read_b64 v[116:117], v10 offset:384
    s_waitcnt lgkmcnt(3)
    v_pk_mul_f32 v[128:129], v[128:129], v[24:25] op_sel_hi:[1,0]
    v_pk_fma_f32 v[200:201], v[200:201], v[164:165], v[128:129] neg_lo:[0,0,1] neg_hi:[0,0,1]
    v_pk_mul_f32 v[130:131], v[130:131], v[24:25] op_sel_hi:[1,0]
    s_waitcnt lgkmcnt(1)
    v_pk_mul_f32 v[132:133], v[132:133], v[24:25] op_sel_hi:[1,0]
    v_pk_fma_f32 v[202:203], v[202:203], v[166:167], v[130:131] neg_lo:[0,0,1] neg_hi:[0,0,1]
    v_cvt_pk_bf16_f32 v66, v200, v201
    v_cvt_pk_bf16_f32 v67, v202, v203
    v_pk_fma_f32 v[204:205], v[204:205], v[168:169], v[132:133] neg_lo:[0,0,1] neg_hi:[0,0,1]
    ds_read_b64 v[120:121], v10 offset:512
    v_pk_mul_f32 v[134:135], v[134:135], v[24:25] op_sel_hi:[1,0]
    v_pk_fma_f32 v[206:207], v[206:207], v[170:171], v[134:135] neg_lo:[0,0,1] neg_hi:[0,0,1]
    v_cvt_pk_bf16_f32 v70, v204, v205
    v_cvt_pk_bf16_f32 v71, v206, v207
    ds_read_b64 v[124:125], v10 offset:640
    s_waitcnt lgkmcnt(2)
    v_pk_mul_f32 v[118:119], v[20:21], v[116:117] op_sel:[0,1] op_sel_hi:[1,1]
    v_pk_fma_f32 v[172:173], v[172:173], v[116:117], v[118:119] op_sel_hi:[1,0,1] neg_lo:[0,0,1] neg_hi:[0,0,1]
    v_pk_mul_f32 v[118:119], v[22:23], v[116:117] op_sel:[0,1] op_sel_hi:[1,1]
    v_pk_fma_f32 v[174:175], v[174:175], v[116:117], v[118:119] op_sel_hi:[1,0,1] neg_lo:[0,0,1] neg_hi:[0,0,1]
    v_cvt_pk_bf16_f32 v42, v172, v173
    v_cvt_pk_bf16_f32 v43, v174, v175
    v_pk_mul_f32 v[118:119], v[16:17], v[116:117] op_sel:[0,1] op_sel_hi:[1,1]
    v_pk_fma_f32 v[136:137], v[136:137], v[116:117], v[118:119] op_sel_hi:[1,0,1] neg_lo:[0,0,1] neg_hi:[0,0,1]
    v_pk_mul_f32 v[118:119], v[18:19], v[116:117] op_sel:[0,1] op_sel_hi:[1,1]
    s_waitcnt lgkmcnt(1)
    v_pk_mul_f32 v[122:123], v[20:21], v[120:121] op_sel:[0,1] op_sel_hi:[1,1]
    v_pk_fma_f32 v[138:139], v[138:139], v[116:117], v[118:119] op_sel_hi:[1,0,1] neg_lo:[0,0,1] neg_hi:[0,0,1]
    v_cvt_pk_bf16_f32 v104, v136, v137
    v_cvt_pk_bf16_f32 v105, v138, v139
    v_pk_fma_f32 v[176:177], v[176:177], v[120:121], v[122:123] op_sel_hi:[1,0,1] neg_lo:[0,0,1] neg_hi:[0,0,1]
    s_waitcnt lgkmcnt(0)
    v_pk_mul_f32 v[126:127], v[20:21], v[124:125] op_sel:[0,1] op_sel_hi:[1,1]
    ds_read_b128 v[172:175], v11 offset:192
    v_pk_mul_f32 v[122:123], v[22:23], v[120:121] op_sel:[0,1] op_sel_hi:[1,1]
    v_pk_fma_f32 v[180:181], v[180:181], v[124:125], v[126:127] op_sel_hi:[1,0,1] neg_lo:[0,0,1] neg_hi:[0,0,1]
    ds_read_b128 v[136:139], v11 offset:768
    v_pk_fma_f32 v[178:179], v[178:179], v[120:121], v[122:123] op_sel_hi:[1,0,1] neg_lo:[0,0,1] neg_hi:[0,0,1]
    v_pk_mul_f32 v[126:127], v[22:23], v[124:125] op_sel:[0,1] op_sel_hi:[1,1]
    v_cvt_pk_bf16_f32 v46, v176, v177
    v_cvt_pk_bf16_f32 v47, v178, v179
    v_pk_fma_f32 v[182:183], v[182:183], v[124:125], v[126:127] op_sel_hi:[1,0,1] neg_lo:[0,0,1] neg_hi:[0,0,1]
    v_pk_mul_f32 v[122:123], v[16:17], v[120:121] op_sel:[0,1] op_sel_hi:[1,1]
    v_cvt_pk_bf16_f32 v50, v180, v181
    v_cvt_pk_bf16_f32 v51, v182, v183
    v_pk_fma_f32 v[140:141], v[140:141], v[120:121], v[122:123] op_sel_hi:[1,0,1] neg_lo:[0,0,1] neg_hi:[0,0,1]
    v_pk_mul_f32 v[122:123], v[18:19], v[120:121] op_sel:[0,1] op_sel_hi:[1,1]
    v_pk_mul_f32 v[126:127], v[16:17], v[124:125] op_sel:[0,1] op_sel_hi:[1,1]
    v_pk_fma_f32 v[142:143], v[142:143], v[120:121], v[122:123] op_sel_hi:[1,0,1] neg_lo:[0,0,1] neg_hi:[0,0,1]
    v_cvt_pk_bf16_f32 v106, v140, v141
    v_pk_fma_f32 v[144:145], v[144:145], v[124:125], v[126:127] op_sel_hi:[1,0,1] neg_lo:[0,0,1] neg_hi:[0,0,1]
    v_cvt_pk_bf16_f32 v107, v142, v143
    ds_read_b128 v[176:179], v11 offset:256
    v_pk_mul_f32 v[126:127], v[18:19], v[124:125] op_sel:[0,1] op_sel_hi:[1,1]
    ds_read_b128 v[140:143], v11 offset:832
    v_pk_fma_f32 v[146:147], v[146:147], v[124:125], v[126:127] op_sel_hi:[1,0,1] neg_lo:[0,0,1] neg_hi:[0,0,1]
    v_cvt_pk_bf16_f32 v108, v144, v145
    v_cvt_pk_bf16_f32 v109, v146, v147
    ds_read_b128 v[180:183], v11 offset:320
    ds_read_b128 v[144:147], v11 offset:896
    s_waitcnt lgkmcnt(4)
    v_pk_mul_f32 v[136:137], v[136:137], v[24:25] op_sel_hi:[1,0]
    v_pk_fma_f32 v[208:209], v[208:209], v[172:173], v[136:137] neg_lo:[0,0,1] neg_hi:[0,0,1]
    v_pk_mul_f32 v[138:139], v[138:139], v[24:25] op_sel_hi:[1,0]
    v_pk_fma_f32 v[210:211], v[210:211], v[174:175], v[138:139] neg_lo:[0,0,1] neg_hi:[0,0,1]
    v_cvt_pk_bf16_f32 v74, v208, v209
    v_cvt_pk_bf16_f32 v75, v210, v211
    ds_read_b64 v[116:117], v10 offset:768
    s_waitcnt lgkmcnt(3)
    v_pk_mul_f32 v[140:141], v[140:141], v[24:25] op_sel_hi:[1,0]
    v_pk_fma_f32 v[212:213], v[212:213], v[176:177], v[140:141] neg_lo:[0,0,1] neg_hi:[0,0,1]
    v_pk_mul_f32 v[142:143], v[142:143], v[24:25] op_sel_hi:[1,0]
    v_pk_fma_f32 v[214:215], v[214:215], v[178:179], v[142:143] neg_lo:[0,0,1] neg_hi:[0,0,1]
    s_waitcnt lgkmcnt(1)
    v_pk_mul_f32 v[144:145], v[144:145], v[24:25] op_sel_hi:[1,0]
    v_cvt_pk_bf16_f32 v78, v212, v213
    v_cvt_pk_bf16_f32 v79, v214, v215
    v_pk_fma_f32 v[216:217], v[216:217], v[180:181], v[144:145] neg_lo:[0,0,1] neg_hi:[0,0,1]
    ds_read_b64 v[120:121], v10 offset:896
    v_pk_mul_f32 v[146:147], v[146:147], v[24:25] op_sel_hi:[1,0]
    v_pk_fma_f32 v[218:219], v[218:219], v[182:183], v[146:147] neg_lo:[0,0,1] neg_hi:[0,0,1]
    v_cvt_pk_bf16_f32 v82, v216, v217
    v_cvt_pk_bf16_f32 v83, v218, v219
    ds_read_b64 v[124:125], v10 offset:1024
    s_waitcnt lgkmcnt(2)
    v_pk_mul_f32 v[118:119], v[20:21], v[116:117] op_sel:[0,1] op_sel_hi:[1,1]
    v_pk_fma_f32 v[184:185], v[184:185], v[116:117], v[118:119] op_sel_hi:[1,0,1] neg_lo:[0,0,1] neg_hi:[0,0,1]
    v_pk_mul_f32 v[118:119], v[22:23], v[116:117] op_sel:[0,1] op_sel_hi:[1,1]
    v_pk_fma_f32 v[186:187], v[186:187], v[116:117], v[118:119] op_sel_hi:[1,0,1] neg_lo:[0,0,1] neg_hi:[0,0,1]
    v_cvt_pk_bf16_f32 v54, v184, v185
    v_cvt_pk_bf16_f32 v55, v186, v187
    v_pk_mul_f32 v[118:119], v[16:17], v[116:117] op_sel:[0,1] op_sel_hi:[1,1]
    v_pk_fma_f32 v[148:149], v[148:149], v[116:117], v[118:119] op_sel_hi:[1,0,1] neg_lo:[0,0,1] neg_hi:[0,0,1]
    v_pk_mul_f32 v[118:119], v[18:19], v[116:117] op_sel:[0,1] op_sel_hi:[1,1]
    v_pk_fma_f32 v[150:151], v[150:151], v[116:117], v[118:119] op_sel_hi:[1,0,1] neg_lo:[0,0,1] neg_hi:[0,0,1]
    v_cvt_pk_bf16_f32 v110, v148, v149
    v_cvt_pk_bf16_f32 v111, v150, v151
    ds_read_b128 v[184:187], v11 offset:384
    ds_read_b128 v[148:151], v11 offset:960
    s_waitcnt lgkmcnt(3)
    v_pk_mul_f32 v[122:123], v[20:21], v[120:121] op_sel:[0,1] op_sel_hi:[1,1]
    v_pk_fma_f32 v[188:189], v[188:189], v[120:121], v[122:123] op_sel_hi:[1,0,1] neg_lo:[0,0,1] neg_hi:[0,0,1]
    v_pk_mul_f32 v[122:123], v[22:23], v[120:121] op_sel:[0,1] op_sel_hi:[1,1]
    v_pk_fma_f32 v[190:191], v[190:191], v[120:121], v[122:123] op_sel_hi:[1,0,1] neg_lo:[0,0,1] neg_hi:[0,0,1]
    v_cvt_pk_bf16_f32 v58, v188, v189
    v_cvt_pk_bf16_f32 v59, v190, v191
    s_waitcnt lgkmcnt(2)
    v_pk_mul_f32 v[126:127], v[20:21], v[124:125] op_sel:[0,1] op_sel_hi:[1,1]
    v_pk_mul_f32 v[122:123], v[16:17], v[120:121] op_sel:[0,1] op_sel_hi:[1,1]
    v_pk_fma_f32 v[192:193], v[192:193], v[124:125], v[126:127] op_sel_hi:[1,0,1] neg_lo:[0,0,1] neg_hi:[0,0,1]
    v_pk_mul_f32 v[126:127], v[22:23], v[124:125] op_sel:[0,1] op_sel_hi:[1,1]
    v_pk_fma_f32 v[152:153], v[152:153], v[120:121], v[122:123] op_sel_hi:[1,0,1] neg_lo:[0,0,1] neg_hi:[0,0,1]
    v_pk_mul_f32 v[122:123], v[18:19], v[120:121] op_sel:[0,1] op_sel_hi:[1,1]
    v_pk_fma_f32 v[194:195], v[194:195], v[124:125], v[126:127] op_sel_hi:[1,0,1] neg_lo:[0,0,1] neg_hi:[0,0,1]
    v_pk_fma_f32 v[154:155], v[154:155], v[120:121], v[122:123] op_sel_hi:[1,0,1] neg_lo:[0,0,1] neg_hi:[0,0,1]
    v_cvt_pk_bf16_f32 v112, v152, v153
    v_cvt_pk_bf16_f32 v62, v192, v193
    v_cvt_pk_bf16_f32 v113, v154, v155
    ds_read_b128 v[188:191], v11 offset:448
    v_cvt_pk_bf16_f32 v63, v194, v195
    ds_read_b128 v[152:155], v11 offset:1024
    v_pk_mul_f32 v[126:127], v[16:17], v[124:125] op_sel:[0,1] op_sel_hi:[1,1]
    v_pk_fma_f32 v[156:157], v[156:157], v[124:125], v[126:127] op_sel_hi:[1,0,1] neg_lo:[0,0,1] neg_hi:[0,0,1]
    v_pk_mul_f32 v[126:127], v[18:19], v[124:125] op_sel:[0,1] op_sel_hi:[1,1]
    v_pk_fma_f32 v[158:159], v[158:159], v[124:125], v[126:127] op_sel_hi:[1,0,1] neg_lo:[0,0,1] neg_hi:[0,0,1]
    v_cvt_pk_bf16_f32 v114, v156, v157
    v_cvt_pk_bf16_f32 v115, v158, v159
    ds_read_b128 v[192:195], v11 offset:512
    ds_read_b128 v[156:159], v11 offset:1088
    s_waitcnt lgkmcnt(4)
    v_pk_mul_f32 v[148:149], v[148:149], v[24:25] op_sel_hi:[1,0]
    v_pk_fma_f32 v[220:221], v[220:221], v[184:185], v[148:149] neg_lo:[0,0,1] neg_hi:[0,0,1]
    v_pk_mul_f32 v[150:151], v[150:151], v[24:25] op_sel_hi:[1,0]
    v_pk_fma_f32 v[222:223], v[222:223], v[186:187], v[150:151] neg_lo:[0,0,1] neg_hi:[0,0,1]
    v_cvt_pk_bf16_f32 v86, v220, v221
    v_cvt_pk_bf16_f32 v87, v222, v223
    s_waitcnt lgkmcnt(2)
    v_pk_mul_f32 v[152:153], v[152:153], v[24:25] op_sel_hi:[1,0]
    v_pk_fma_f32 v[224:225], v[224:225], v[188:189], v[152:153] neg_lo:[0,0,1] neg_hi:[0,0,1]
    v_pk_mul_f32 v[154:155], v[154:155], v[24:25] op_sel_hi:[1,0]
    v_pk_fma_f32 v[226:227], v[226:227], v[190:191], v[154:155] neg_lo:[0,0,1] neg_hi:[0,0,1]
    v_cvt_pk_bf16_f32 v90, v224, v225
    v_cvt_pk_bf16_f32 v91, v226, v227
    s_waitcnt lgkmcnt(0)
    v_pk_mul_f32 v[156:157], v[156:157], v[24:25] op_sel_hi:[1,0]
    v_pk_fma_f32 v[228:229], v[228:229], v[192:193], v[156:157] neg_lo:[0,0,1] neg_hi:[0,0,1]
    v_pk_mul_f32 v[158:159], v[158:159], v[24:25] op_sel_hi:[1,0]
    v_pk_fma_f32 v[230:231], v[230:231], v[194:195], v[158:159] neg_lo:[0,0,1] neg_hi:[0,0,1]
    v_cvt_pk_bf16_f32 v94, v228, v229
    v_cvt_pk_bf16_f32 v95, v230, v231
    v_cndmask_b32_e64 v32, v96, v34, s[68:69]
    v_cndmask_b32_e64 v36, v38, v96, s[68:69]
    v_cndmask_b32_e64 v40, v34, v42, s[68:69]
    v_cndmask_b32_e64 v44, v46, v38, s[68:69]
    v_cndmask_b32_e64 v48, v42, v50, s[68:69]
    v_cndmask_b32_e64 v52, v54, v46, s[68:69]
    v_cndmask_b32_e64 v56, v50, v58, s[68:69]
    v_cndmask_b32_e64 v60, v62, v54, s[68:69]
    v_cndmask_b32_e64 v64, v98, v66, s[70:71]
    v_cndmask_b32_e64 v68, v70, v98, s[70:71]
    v_cndmask_b32_e64 v72, v66, v74, s[70:71]
    v_cndmask_b32_e64 v76, v78, v70, s[70:71]
    v_cndmask_b32_e64 v80, v74, v82, s[70:71]
    v_cndmask_b32_e64 v84, v86, v78, s[70:71]
    v_cndmask_b32_e64 v88, v82, v90, s[70:71]
    v_cndmask_b32_e64 v92, v94, v86, s[70:71]
    v_cndmask_b32_e64 v33, v97, v35, s[68:69]
    v_cndmask_b32_e64 v37, v39, v97, s[68:69]
    v_cndmask_b32_e64 v41, v35, v43, s[68:69]
    v_cndmask_b32_e64 v45, v47, v39, s[68:69]
    v_cndmask_b32_e64 v49, v43, v51, s[68:69]
    v_cndmask_b32_e64 v53, v55, v47, s[68:69]
    v_cndmask_b32_e64 v57, v51, v59, s[68:69]
    v_cndmask_b32_e64 v61, v63, v55, s[68:69]
    v_cndmask_b32_e64 v65, v99, v67, s[70:71]
    v_cndmask_b32_e64 v69, v71, v99, s[70:71]
    v_cndmask_b32_e64 v73, v67, v75, s[70:71]
    v_cndmask_b32_e64 v77, v79, v71, s[70:71]
    v_cndmask_b32_e64 v81, v75, v83, s[70:71]
    v_cndmask_b32_e64 v85, v87, v79, s[70:71]
    v_cndmask_b32_e64 v89, v83, v91, s[70:71]
    v_cndmask_b32_e64 v93, v95, v87, s[70:71]
    v_and_b32 v128, v244, v100
    v_and_b32 v140, v245, v102
    v_and_b32 v152, v244, v104
    v_and_b32 v164, v245, v106
    v_and_b32 v176, v244, v108
    v_and_b32 v188, v245, v110
    v_and_b32 v200, v244, v112
    v_and_b32 v212, v245, v114
    v_and_b32 v129, v244, v101
    v_and_b32 v141, v245, v103
    v_and_b32 v153, v244, v105
    v_and_b32 v165, v245, v107
    v_and_b32 v177, v244, v109
    v_and_b32 v189, v245, v111
    v_and_b32 v201, v244, v113
    v_and_b32 v213, v245, v115
    v_and_b32 v130, v245, v100
    v_and_b32 v142, v244, v102
    v_and_b32 v154, v245, v104
    v_and_b32 v166, v244, v106
    v_and_b32 v178, v245, v108
    v_and_b32 v190, v244, v110
    v_and_b32 v202, v245, v112
    v_and_b32 v214, v244, v114
    v_and_b32 v131, v245, v101
    v_and_b32 v143, v244, v103
    v_and_b32 v155, v245, v105
    v_and_b32 v167, v244, v107
    v_and_b32 v179, v245, v109
    v_and_b32 v191, v244, v111
    v_and_b32 v203, v245, v113
    v_and_b32 v215, v244, v115
    v_mfma_f32_16x16x32_bf16 v[132:135], v[32:35], v[128:131], v[236:239]
    v_mfma_f32_16x16x32_bf16 v[144:147], v[36:39], v[140:143], v[240:243]
    v_mfma_f32_16x16x32_bf16 v[156:159], v[40:43], v[152:155], v[232:235]
    v_mfma_f32_16x16x32_bf16 v[168:171], v[44:47], v[164:167], v[232:235]
    v_mfma_f32_16x16x32_bf16 v[180:183], v[48:51], v[176:179], v[232:235]
    v_mfma_f32_16x16x32_bf16 v[192:195], v[52:55], v[188:191], v[232:235]
    v_mfma_f32_16x16x32_bf16 v[204:207], v[56:59], v[200:203], v[232:235]
    v_mfma_f32_16x16x32_bf16 v[216:219], v[60:63], v[212:215], v[232:235]
    s_nop 0
    v_max3_f32 v224, v132, v133, v134
    v_max3_f32 v225, v144, v145, v146
    v_max3_f32 v226, v156, v157, v158
    v_max3_f32 v227, v168, v169, v170
    v_max3_f32 v228, v180, v181, v182
    v_max3_f32 v229, v192, v193, v194
    v_max_f32 v224, v224, v135
    v_max_f32 v225, v225, v147
    ds_swizzle_b32 v247, v224 offset:0x401F
    ds_swizzle_b32 v248, v225 offset:0x401F
    v_max_f32 v226, v226, v159
    v_max_f32 v227, v227, v171
    v_max_f32 v228, v228, v183
    v_max_f32 v229, v229, v195
    v_max3_f32 v230, v204, v205, v206
    v_max3_f32 v231, v216, v217, v218
    ds_swizzle_b32 v249, v226 offset:0x401F
    ds_swizzle_b32 v250, v227 offset:0x401F
    ds_swizzle_b32 v251, v228 offset:0x401F
    ds_swizzle_b32 v252, v229 offset:0x401F
    v_max_f32 v230, v230, v207
    v_max_f32 v231, v231, v219
    ds_swizzle_b32 v253, v230 offset:0x401F
    ds_swizzle_b32 v254, v231 offset:0x401F
    s_waitcnt lgkmcnt(7)
    v_max_f32 v224, v224, v247
    s_waitcnt lgkmcnt(6)
    v_max_f32 v225, v225, v248
    ds_bpermute_b32 v247, v246, v224
    ds_bpermute_b32 v248, v246, v225
    s_waitcnt lgkmcnt(7)
    v_max_f32 v226, v226, v249
    s_waitcnt lgkmcnt(6)
    v_max_f32 v227, v227, v250
    ds_bpermute_b32 v249, v246, v226
    ds_bpermute_b32 v250, v246, v227
    s_waitcnt lgkmcnt(7)
    v_max_f32 v228, v228, v251
    s_waitcnt lgkmcnt(6)
    v_max_f32 v229, v229, v252
    ds_bpermute_b32 v251, v246, v228
    ds_bpermute_b32 v252, v246, v229
    s_waitcnt lgkmcnt(7)
    v_max_f32 v230, v230, v253
    s_waitcnt lgkmcnt(6)
    v_max_f32 v231, v231, v254
    ds_bpermute_b32 v253, v246, v230
    ds_bpermute_b32 v254, v246, v231
    s_waitcnt lgkmcnt(7)
    v_max_f32 v224, v224, v247
    s_waitcnt lgkmcnt(6)
    v_max_f32 v225, v225, v248
    v_mul_f32 v224, s72, v224
    v_mul_f32 v225, s72, v225
    v_fma_f32 v132, v132, s72, -v224
    v_fma_f32 v133, v133, s72, -v224
    v_fma_f32 v134, v134, s72, -v224
    v_fma_f32 v135, v135, s72, -v224
    v_exp_f32 v132, v132
    v_fma_f32 v144, v144, s72, -v225
    s_waitcnt lgkmcnt(5)
    v_max_f32 v226, v226, v249
    s_waitcnt lgkmcnt(4)
    v_max_f32 v227, v227, v250
    s_waitcnt lgkmcnt(3)
    v_max_f32 v228, v228, v251
    s_waitcnt lgkmcnt(2)
    v_max_f32 v229, v229, v252
    v_exp_f32 v133, v133
    s_waitcnt lgkmcnt(0)
    v_max_f32 v231, v231, v254
    v_exp_f32 v134, v134
    v_fma_f32 v145, v145, s72, -v225
    v_mul_f32 v226, s72, v226
    v_mul_f32 v227, s72, v227
    v_mul_f32 v228, s72, v228
    v_mul_f32 v229, s72, v229
    v_max_f32 v230, v230, v253
    v_mul_f32 v231, s72, v231
    v_exp_f32 v135, v135
    v_fma_f32 v146, v146, s72, -v225
    v_fma_f32 v156, v156, s72, -v226
    v_fma_f32 v168, v168, s72, -v227
    v_fma_f32 v180, v180, s72, -v228
    v_fma_f32 v192, v192, s72, -v229
    v_mul_f32 v230, s72, v230
    v_fma_f32 v216, v216, s72, -v231
    v_cvt_pk_bf16_f32 v136, v132, v133
    v_fma_f32 v147, v147, s72, -v225
    v_fma_f32 v157, v157, s72, -v226
    v_fma_f32 v169, v169, s72, -v227
    v_fma_f32 v181, v181, s72, -v228
    v_fma_f32 v193, v193, s72, -v229
    v_fma_f32 v204, v204, s72, -v230
    v_fma_f32 v217, v217, s72, -v231
    v_cvt_pk_bf16_f32 v137, v134, v135
    v_exp_f32 v144, v144
    v_fma_f32 v158, v158, s72, -v226
    v_fma_f32 v170, v170, s72, -v227
    v_fma_f32 v182, v182, s72, -v228
    v_fma_f32 v194, v194, s72, -v229
    v_fma_f32 v205, v205, s72, -v230
    v_fma_f32 v218, v218, s72, -v231
    v_and_b32 v128, v244, v136
    v_exp_f32 v145, v145
    v_fma_f32 v159, v159, s72, -v226
    v_fma_f32 v171, v171, s72, -v227
    v_fma_f32 v183, v183, s72, -v228
    v_fma_f32 v195, v195, s72, -v229
    v_fma_f32 v206, v206, s72, -v230
    v_fma_f32 v219, v219, s72, -v231
    v_and_b32 v129, v244, v137
    v_exp_f32 v146, v146
    v_exp_f32 v156, v156
    v_exp_f32 v168, v168
    v_exp_f32 v180, v180
    v_exp_f32 v192, v192
    v_fma_f32 v207, v207, s72, -v230
    v_exp_f32 v216, v216
    v_and_b32 v130, v245, v136
    v_exp_f32 v147, v147
    v_exp_f32 v157, v157
    v_exp_f32 v169, v169
    v_exp_f32 v181, v181
    v_exp_f32 v193, v193
    v_exp_f32 v204, v204
    v_exp_f32 v217, v217
    v_and_b32 v131, v245, v137
    v_cvt_pk_bf16_f32 v148, v144, v145
    v_exp_f32 v158, v158
    v_exp_f32 v170, v170
    v_exp_f32 v182, v182
    v_exp_f32 v194, v194
    v_exp_f32 v205, v205
    v_exp_f32 v218, v218
    v_mfma_f32_16x16x32_bf16 v[132:135], v[64:67], v[128:131], 0
    v_cvt_pk_bf16_f32 v149, v146, v147
    v_exp_f32 v159, v159
    v_exp_f32 v171, v171
    v_exp_f32 v183, v183
    v_exp_f32 v195, v195
    v_exp_f32 v206, v206
    v_exp_f32 v219, v219
    v_mfma_f32_16x16x32_bf16 v[136:139], v[28:31], v[128:131], 0
    v_and_b32 v140, v245, v148
    v_cvt_pk_bf16_f32 v160, v156, v157
    v_cvt_pk_bf16_f32 v172, v168, v169
    v_cvt_pk_bf16_f32 v184, v180, v181
    v_cvt_pk_bf16_f32 v196, v192, v193
    v_exp_f32 v207, v207
    v_cvt_pk_bf16_f32 v220, v216, v217
    v_and_b32 v141, v245, v149
    v_and_b32 v142, v244, v148
    v_cvt_pk_bf16_f32 v161, v158, v159
    v_cvt_pk_bf16_f32 v173, v170, v171
    v_cvt_pk_bf16_f32 v185, v182, v183
    v_cvt_pk_bf16_f32 v197, v194, v195
    v_cvt_pk_bf16_f32 v208, v204, v205
    v_cvt_pk_bf16_f32 v221, v218, v219
    v_rcp_f32 v224, v136
    v_and_b32 v143, v244, v149
    v_and_b32 v152, v244, v160
    v_and_b32 v164, v245, v172
    v_and_b32 v176, v244, v184
    v_and_b32 v188, v245, v196
    v_cvt_pk_bf16_f32 v209, v206, v207
    v_and_b32 v212, v245, v220
    v_mul_f32 v132, v132, v224
    v_mfma_f32_16x16x32_bf16 v[144:147], v[68:71], v[140:143], 0
    v_and_b32 v153, v244, v161
    v_and_b32 v165, v245, v173
    v_and_b32 v177, v244, v185
    v_and_b32 v189, v245, v197
    v_and_b32 v200, v244, v208
    v_and_b32 v213, v245, v221
    v_mul_f32 v133, v133, v224
    v_mfma_f32_16x16x32_bf16 v[148:151], v[28:31], v[140:143], 0
    v_and_b32 v154, v245, v160
    v_and_b32 v166, v244, v172
    v_and_b32 v178, v245, v184
    v_and_b32 v190, v244, v196
    v_and_b32 v201, v244, v209
    v_and_b32 v214, v244, v220
    v_mul_f32 v134, v134, v224
    v_and_b32 v155, v245, v161
    v_and_b32 v167, v244, v173
    v_and_b32 v179, v245, v185
    v_and_b32 v191, v244, v197
    v_and_b32 v202, v245, v208
    v_and_b32 v203, v245, v209
    v_and_b32 v215, v244, v221
    v_mul_f32 v135, v135, v224
    v_rcp_f32 v225, v148
    v_mfma_f32_16x16x32_bf16 v[156:159], v[72:75], v[152:155], 0
    v_mfma_f32_16x16x32_bf16 v[168:171], v[76:79], v[164:167], 0
    v_mfma_f32_16x16x32_bf16 v[180:183], v[80:83], v[176:179], 0
    v_mfma_f32_16x16x32_bf16 v[192:195], v[84:87], v[188:191], 0
    v_mfma_f32_16x16x32_bf16 v[204:207], v[88:91], v[200:203], 0
    v_mfma_f32_16x16x32_bf16 v[216:219], v[92:95], v[212:215], 0
    v_cvt_pk_bf16_f32 v100, v132, v133
    v_mul_f32 v144, v144, v225
    v_mfma_f32_16x16x32_bf16 v[160:163], v[28:31], v[152:155], 0
    v_mfma_f32_16x16x32_bf16 v[172:175], v[28:31], v[164:167], 0
    v_mfma_f32_16x16x32_bf16 v[184:187], v[28:31], v[176:179], 0
    v_mfma_f32_16x16x32_bf16 v[196:199], v[28:31], v[188:191], 0
    v_mfma_f32_16x16x32_bf16 v[208:211], v[28:31], v[200:203], 0
    v_mfma_f32_16x16x32_bf16 v[220:223], v[28:31], v[212:215], 0
    v_cvt_pk_bf16_f32 v101, v134, v135
    v_mul_f32 v145, v145, v225
    v_mul_f32 v146, v146, v225
    v_rcp_f32 v226, v160
    v_rcp_f32 v227, v172
    v_rcp_f32 v228, v184
    v_rcp_f32 v229, v196
    v_rcp_f32 v230, v208
    v_rcp_f32 v231, v220
    v_mul_f32 v147, v147, v225
    v_mul_f32 v156, v156, v226
    v_mul_f32 v168, v168, v227
    v_mul_f32 v180, v180, v228
    v_mul_f32 v192, v192, v229
    v_mul_f32 v204, v204, v230
    v_mul_f32 v216, v216, v231
    v_cvt_pk_bf16_f32 v102, v144, v145
    v_mul_f32 v157, v157, v226
    v_mul_f32 v169, v169, v227
    v_mul_f32 v181, v181, v228
    v_mul_f32 v193, v193, v229
    v_mul_f32 v205, v205, v230
    v_mul_f32 v217, v217, v231
    v_cvt_pk_bf16_f32 v103, v146, v147
    v_mul_f32 v158, v158, v226
    v_mul_f32 v170, v170, v227
    v_mul_f32 v182, v182, v228
    v_mul_f32 v194, v194, v229
    v_mul_f32 v206, v206, v230
    v_mul_f32 v218, v218, v231
    v_mul_f32 v159, v159, v226
    v_mul_f32 v171, v171, v227
    v_mul_f32 v183, v183, v228
    v_mul_f32 v195, v195, v229
    v_mul_f32 v207, v207, v230
    v_mul_f32 v219, v219, v231
    v_cvt_pk_bf16_f32 v104, v156, v157
    v_cvt_pk_bf16_f32 v106, v168, v169
    v_cvt_pk_bf16_f32 v108, v180, v181
    v_cvt_pk_bf16_f32 v110, v192, v193
    v_cvt_pk_bf16_f32 v112, v204, v205
    v_cvt_pk_bf16_f32 v114, v216, v217
    v_cvt_pk_bf16_f32 v105, v158, v159
    v_cvt_pk_bf16_f32 v111, v194, v195
    v_cvt_pk_bf16_f32 v107, v170, v171
    v_cvt_pk_bf16_f32 v109, v182, v183
    v_cvt_pk_bf16_f32 v113, v206, v207
    v_cvt_pk_bf16_f32 v115, v218, v219
    s_lshl_b32 s13, s9, 2
    s_mul_i32 s13, s13, 118
    s_lshl_b32 s14, s10, 2
    s_add_u32 s13, s13, s14
    s_add_u32 s13, s13, s8
    s_lshl_b32 s13, s13, 10
    v_lshlrev_b32 v8, 4, v0
    v_add_u32 v8, s13, v8
    v_permlane16_swap_b32 v100, v102
    v_permlane16_swap_b32 v101, v103
    v_permlane16_swap_b32 v104, v106
    v_permlane16_swap_b32 v105, v107
    v_permlane16_swap_b32 v108, v110
    v_permlane16_swap_b32 v109, v111
    v_permlane16_swap_b32 v112, v114
    v_permlane16_swap_b32 v113, v115
    global_store_dwordx4 v8, v[100:103], s[36:37] sc1
    s_nop 1
    v_add_u32 v8, 120832, v8
    global_store_dwordx4 v8, v[104:107], s[36:37] sc1
    s_nop 1
    v_add_u32 v8, 120832, v8
    global_store_dwordx4 v8, v[108:111], s[36:37] sc1
    s_nop 1
    v_add_u32 v8, 120832, v8
    global_store_dwordx4 v8, v[112:115], s[36:37] sc1
    s_branch L_cons_pub
L_cons_mlp:
    s_barrier
    v_and_b32 v14, 31, v0
    v_lshrrev_b32 v15, 5, v0
    s_lshl_b32 s13, s8, 5
    s_add_u32 s13, s13, 16
    v_add_u32 v16, s13, v14
    v_lshrrev_b32 v17, 1, v16
    v_and_b32 v17, 7, v17
    v_xor_b32 v17, v15, v17
    v_lshlrev_b32 v16, 7, v16
    v_lshl_add_u32 v8, v17, 4, v16
    v_xor_b32 v9, 32, v8
    v_xor_b32 v10, 64, v8
    v_xor_b32 v11, 96, v8
    v_and_b32 v16, 15, v0
    v_lshrrev_b32 v16, 2, v16
    v_lshl_add_u32 v16, v15, 3, v16
    v_lshrrev_b32 v17, 4, v0
    v_and_b32 v17, 1, v17
    v_and_b32 v18, 1, v0
    v_lshrrev_b32 v19, 1, v0
    v_and_b32 v19, 1, v19
    v_lshl_add_u32 v17, v17, 1, v18
    v_lshrrev_b32 v18, 1, v16
    v_and_b32 v18, 1, v18
    v_lshlrev_b32 v18, 2, v18
    v_xor_b32 v17, v17, v18
    v_lshlrev_b32 v16, 7, v16
    v_lshl_add_u32 v16, v17, 4, v16
    v_lshl_add_u32 v16, v19, 3, v16
    v_add_u32 v12, 18432, v16
    v_xor_b32 v13, 64, v12
    v_mov_b32 v14, 0
    v_mov_b32 v15, 0
    v_mov_b32 v16, 0
    v_mov_b32 v17, 0
    s_nop 1
    v_mfma_f32_32x32x16_bf16 v[128:143], v[14:17], v[14:17], 0
    v_mfma_f32_32x32x16_bf16 v[144:159], v[14:17], v[14:17], 0
    v_mfma_f32_32x32x16_bf16 v[160:175], v[14:17], v[14:17], 0
    v_mfma_f32_32x32x16_bf16 v[176:191], v[14:17], v[14:17], 0
    v_mfma_f32_32x32x16_bf16 v[192:207], v[14:17], v[14:17], 0
    v_mfma_f32_32x32x16_bf16 v[208:223], v[14:17], v[14:17], 0
    s_waitcnt lgkmcnt(0)
    s_mov_b32 s40, s16
    s_and_b32 s41, s17, 0xffff
    s_mov_b32 s42, 2097152
    s_mov_b32 s43, 0x20000
    s_cmp_eq_u32 s11, 0
    s_cselect_b32 s44, s18, s24
    s_cselect_b32 s45, s19, s25
    s_mov_b32 s46, 1409024
    s_cselect_b32 s46, 1572864, s46
    s_and_b32 s45, s45, 0xffff
    s_mov_b32 s47, 0x20000
    s_add_u32 s64, s36, 8650752
    s_addc_u32 s65, s37, 0
    s_cmp_eq_u32 s11, 1
    s_cbranch_scc0 L_cons_m5
    s_mov_b32 s60, 0
    v_mov_b32 v21, 0x3f803f80
    v_and_b32 v17, 3, v0
    v_lshrrev_b32 v18, 2, v0
    v_and_b32 v18, 1, v18
    v_lshl_add_u32 v17, v18, 3, v17
    v_lshrrev_b32 v18, 3, v0
    v_and_b32 v18, 1, v18
    v_lshl_add_u32 v17, v18, 2, v17
    v_lshrrev_b32 v18, 4, v0
    v_and_b32 v18, 1, v18
    v_lshl_add_u32 v17, v18, 4, v17
    v_lshrrev_b32 v18, 5, v0
    s_lshl_b32 s13, s8, 1
    v_add_u32 v18, s13, v18
    v_mul_u32_u24 v18, 192, v18
    v_add_u32 v17, v17, v18
    v_lshlrev_b32 v20, 2, v17
    v_add_u32 v20, 132096, v20
    s_barrier
    v_add_u32 v1, s60, v8
    v_add_u32 v2, s60, v9
    v_add_u32 v3, s60, v10
    v_add_u32 v4, s60, v11
    v_add_u32 v5, s60, v12
    v_add_u32 v6, s60, v13
    ds_read_b128 v[32:35], v1
    ds_read_b64_tr_b16 v[36:37], v5 offset:0
    ds_read_b64_tr_b16 v[38:39], v5 offset:512
    ds_read_b64_tr_b16 v[40:41], v6 offset:0
    ds_read_b64_tr_b16 v[42:43], v6 offset:512
    ds_read_b64_tr_b16 v[44:45], v5 offset:8192
    ds_read_b64_tr_b16 v[46:47], v5 offset:8704
    ds_read_b64_tr_b16 v[48:49], v6 offset:8192
    ds_read_b64_tr_b16 v[50:51], v6 offset:8704
    ds_read_b64_tr_b16 v[52:53], v5 offset:16384
    ds_read_b64_tr_b16 v[54:55], v5 offset:16896
    ds_read_b64_tr_b16 v[56:57], v6 offset:16384
    ds_read_b64_tr_b16 v[58:59], v6 offset:16896
    s_waitcnt lgkmcnt(0)
    v_mfma_f32_32x32x16_bf16 v[128:143], v[36:39], v[32:35], v[128:143]
    ds_read_b128 v[64:67], v2
    ds_read_b64_tr_b16 v[68:69], v5 offset:2048
    ds_read_b64_tr_b16 v[70:71], v5 offset:2560
    v_mfma_f32_32x32x16_bf16 v[144:159], v[40:43], v[32:35], v[144:159]
    ds_read_b64_tr_b16 v[72:73], v6 offset:2048
    ds_read_b64_tr_b16 v[74:75], v6 offset:2560
    ds_read_b64_tr_b16 v[76:77], v5 offset:10240
    v_mfma_f32_32x32x16_bf16 v[160:175], v[44:47], v[32:35], v[160:175]
    ds_read_b64_tr_b16 v[78:79], v5 offset:10752
    ds_read_b64_tr_b16 v[80:81], v6 offset:10240
    ds_read_b64_tr_b16 v[82:83], v6 offset:10752
    v_mfma_f32_32x32x16_bf16 v[176:191], v[48:51], v[32:35], v[176:191]
    ds_read_b64_tr_b16 v[84:85], v5 offset:18432
    ds_read_b64_tr_b16 v[86:87], v5 offset:18944
    ds_read_b64_tr_b16 v[88:89], v6 offset:18432
    v_mfma_f32_32x32x16_bf16 v[192:207], v[52:55], v[32:35], v[192:207]
    ds_read_b64_tr_b16 v[90:91], v6 offset:18944
    v_mfma_f32_32x32x16_bf16 v[208:223], v[56:59], v[32:35], v[208:223]
    s_and_b32 s13, s78, 1
    s_cbranch_scc0 Lmcs_44
    s_cmp_eq_u32 s8, 0
    s_cbranch_scc0 Lmcs_44
    v_dot2_f32_bf16 v24, v36, v21, 0
    v_dot2_f32_bf16 v24, v37, v21, v24
    v_dot2_f32_bf16 v24, v38, v21, v24
    v_dot2_f32_bf16 v24, v39, v21, v24
    v_dot2_f32_bf16 v25, v40, v21, 0
    v_dot2_f32_bf16 v25, v41, v21, v25
    v_dot2_f32_bf16 v25, v42, v21, v25
    v_dot2_f32_bf16 v25, v43, v21, v25
    v_dot2_f32_bf16 v26, v44, v21, 0
    v_dot2_f32_bf16 v26, v45, v21, v26
    v_dot2_f32_bf16 v26, v46, v21, v26
    v_dot2_f32_bf16 v26, v47, v21, v26
    v_dot2_f32_bf16 v27, v48, v21, 0
    v_dot2_f32_bf16 v27, v49, v21, v27
    v_dot2_f32_bf16 v27, v50, v21, v27
    v_dot2_f32_bf16 v27, v51, v21, v27
    v_dot2_f32_bf16 v28, v52, v21, 0
    v_dot2_f32_bf16 v28, v53, v21, v28
    v_dot2_f32_bf16 v28, v54, v21, v28
    v_dot2_f32_bf16 v28, v55, v21, v28
    v_dot2_f32_bf16 v29, v56, v21, 0
    v_dot2_f32_bf16 v29, v57, v21, v29
    v_dot2_f32_bf16 v29, v58, v21, v29
    v_dot2_f32_bf16 v29, v59, v21, v29
Lmcs_44:
    s_waitcnt lgkmcnt(0)
    v_mfma_f32_32x32x16_bf16 v[128:143], v[68:71], v[64:67], v[128:143]
    ds_read_b128 v[32:35], v3
    ds_read_b64_tr_b16 v[36:37], v5 offset:4096
    ds_read_b64_tr_b16 v[38:39], v5 offset:4608
    v_mfma_f32_32x32x16_bf16 v[144:159], v[72:75], v[64:67], v[144:159]
    ds_read_b64_tr_b16 v[40:41], v6 offset:4096
    ds_read_b64_tr_b16 v[42:43], v6 offset:4608
    ds_read_b64_tr_b16 v[44:45], v5 offset:12288
    v_mfma_f32_32x32x16_bf16 v[160:175], v[76:79], v[64:67], v[160:175]
    ds_read_b64_tr_b16 v[46:47], v5 offset:12800
    ds_read_b64_tr_b16 v[48:49], v6 offset:12288
    ds_read_b64_tr_b16 v[50:51], v6 offset:12800
    v_mfma_f32_32x32x16_bf16 v[176:191], v[80:83], v[64:67], v[176:191]
    ds_read_b64_tr_b16 v[52:53], v5 offset:20480
    ds_read_b64_tr_b16 v[54:55], v5 offset:20992
    ds_read_b64_tr_b16 v[56:57], v6 offset:20480
    v_mfma_f32_32x32x16_bf16 v[192:207], v[84:87], v[64:67], v[192:207]
    ds_read_b64_tr_b16 v[58:59], v6 offset:20992
    v_mfma_f32_32x32x16_bf16 v[208:223], v[88:91], v[64:67], v[208:223]
    s_and_b32 s13, s78, 1
    s_cbranch_scc0 Lmcs_45
    s_cmp_eq_u32 s8, 1
    s_cbranch_scc0 Lmcs_45
    v_dot2_f32_bf16 v24, v68, v21, 0
    v_dot2_f32_bf16 v24, v69, v21, v24
    v_dot2_f32_bf16 v24, v70, v21, v24
    v_dot2_f32_bf16 v24, v71, v21, v24
    v_dot2_f32_bf16 v25, v72, v21, 0
    v_dot2_f32_bf16 v25, v73, v21, v25
    v_dot2_f32_bf16 v25, v74, v21, v25
    v_dot2_f32_bf16 v25, v75, v21, v25
    v_dot2_f32_bf16 v26, v76, v21, 0
    v_dot2_f32_bf16 v26, v77, v21, v26
    v_dot2_f32_bf16 v26, v78, v21, v26
    v_dot2_f32_bf16 v26, v79, v21, v26
    v_dot2_f32_bf16 v27, v80, v21, 0
    v_dot2_f32_bf16 v27, v81, v21, v27
    v_dot2_f32_bf16 v27, v82, v21, v27
    v_dot2_f32_bf16 v27, v83, v21, v27
    v_dot2_f32_bf16 v28, v84, v21, 0
    v_dot2_f32_bf16 v28, v85, v21, v28
    v_dot2_f32_bf16 v28, v86, v21, v28
    v_dot2_f32_bf16 v28, v87, v21, v28
    v_dot2_f32_bf16 v29, v88, v21, 0
    v_dot2_f32_bf16 v29, v89, v21, v29
    v_dot2_f32_bf16 v29, v90, v21, v29
    v_dot2_f32_bf16 v29, v91, v21, v29
Lmcs_45:
    s_waitcnt lgkmcnt(0)
    v_mfma_f32_32x32x16_bf16 v[128:143], v[36:39], v[32:35], v[128:143]
    ds_read_b128 v[64:67], v4
    ds_read_b64_tr_b16 v[68:69], v5 offset:6144
    ds_read_b64_tr_b16 v[70:71], v5 offset:6656
    v_mfma_f32_32x32x16_bf16 v[144:159], v[40:43], v[32:35], v[144:159]
    ds_read_b64_tr_b16 v[72:73], v6 offset:6144
    ds_read_b64_tr_b16 v[74:75], v6 offset:6656
    ds_read_b64_tr_b16 v[76:77], v5 offset:14336
    v_mfma_f32_32x32x16_bf16 v[160:175], v[44:47], v[32:35], v[160:175]
    ds_read_b64_tr_b16 v[78:79], v5 offset:14848
    ds_read_b64_tr_b16 v[80:81], v6 offset:14336
    ds_read_b64_tr_b16 v[82:83], v6 offset:14848
    v_mfma_f32_32x32x16_bf16 v[176:191], v[48:51], v[32:35], v[176:191]
    ds_read_b64_tr_b16 v[84:85], v5 offset:22528
    ds_read_b64_tr_b16 v[86:87], v5 offset:23040
    ds_read_b64_tr_b16 v[88:89], v6 offset:22528
    v_mfma_f32_32x32x16_bf16 v[192:207], v[52:55], v[32:35], v[192:207]
    ds_read_b64_tr_b16 v[90:91], v6 offset:23040
    v_mfma_f32_32x32x16_bf16 v[208:223], v[56:59], v[32:35], v[208:223]
    s_and_b32 s13, s78, 1
    s_cbranch_scc0 Lmcs_46
    s_cmp_eq_u32 s8, 2
    s_cbranch_scc0 Lmcs_46
    v_dot2_f32_bf16 v24, v36, v21, 0
    v_dot2_f32_bf16 v24, v37, v21, v24
    v_dot2_f32_bf16 v24, v38, v21, v24
    v_dot2_f32_bf16 v24, v39, v21, v24
    v_dot2_f32_bf16 v25, v40, v21, 0
    v_dot2_f32_bf16 v25, v41, v21, v25
    v_dot2_f32_bf16 v25, v42, v21, v25
    v_dot2_f32_bf16 v25, v43, v21, v25
    v_dot2_f32_bf16 v26, v44, v21, 0
    v_dot2_f32_bf16 v26, v45, v21, v26
    v_dot2_f32_bf16 v26, v46, v21, v26
    v_dot2_f32_bf16 v26, v47, v21, v26
    v_dot2_f32_bf16 v27, v48, v21, 0
    v_dot2_f32_bf16 v27, v49, v21, v27
    v_dot2_f32_bf16 v27, v50, v21, v27
    v_dot2_f32_bf16 v27, v51, v21, v27
    v_dot2_f32_bf16 v28, v52, v21, 0
    v_dot2_f32_bf16 v28, v53, v21, v28
    v_dot2_f32_bf16 v28, v54, v21, v28
    v_dot2_f32_bf16 v28, v55, v21, v28
    v_dot2_f32_bf16 v29, v56, v21, 0
    v_dot2_f32_bf16 v29, v57, v21, v29
    v_dot2_f32_bf16 v29, v58, v21, v29
    v_dot2_f32_bf16 v29, v59, v21, v29
Lmcs_46:
    s_waitcnt lgkmcnt(0)
    v_mfma_f32_32x32x16_bf16 v[128:143], v[68:71], v[64:67], v[128:143]
    s_barrier
    s_add_u32 s60, s60, 43008
    s_cmp_eq_u32 s60, 129024
    s_cselect_b32 s60, 0, s60
    v_mfma_f32_32x32x16_bf16 v[144:159], v[72:75], v[64:67], v[144:159]
    v_add_u32 v1, s60, v8
    v_add_u32 v2, s60, v9
    v_add_u32 v3, s60, v10
    v_add_u32 v4, s60, v11
    v_add_u32 v5, s60, v12
    v_add_u32 v6, s60, v13
    v_mfma_f32_32x32x16_bf16 v[160:175], v[76:79], v[64:67], v[160:175]
    ds_read_b128 v[32:35], v1
    ds_read_b64_tr_b16 v[36:37], v5 offset:0
    ds_read_b64_tr_b16 v[38:39], v5 offset:512
    ds_read_b64_tr_b16 v[40:41], v6 offset:0
    v_mfma_f32_32x32x16_bf16 v[176:191], v[80:83], v[64:67], v[176:191]
    ds_read_b64_tr_b16 v[42:43], v6 offset:512
    ds_read_b64_tr_b16 v[44:45], v5 offset:8192
    ds_read_b64_tr_b16 v[46:47], v5 offset:8704
    ds_read_b64_tr_b16 v[48:49], v6 offset:8192
    v_mfma_f32_32x32x16_bf16 v[192:207], v[84:87], v[64:67], v[192:207]
    ds_read_b64_tr_b16 v[50:51], v6 offset:8704
    ds_read_b64_tr_b16 v[52:53], v5 offset:16384
    ds_read_b64_tr_b16 v[54:55], v5 offset:16896
    ds_read_b64_tr_b16 v[56:57], v6 offset:16384
    v_mfma_f32_32x32x16_bf16 v[208:223], v[88:91], v[64:67], v[208:223]
    ds_read_b64_tr_b16 v[58:59], v6 offset:16896
    s_and_b32 s13, s78, 1
    s_cbranch_scc0 Lmcs_47
    s_cmp_eq_u32 s8, 3
    s_cbranch_scc0 Lmcs_47
    v_dot2_f32_bf16 v24, v68, v21, 0
    v_dot2_f32_bf16 v24, v69, v21, v24
    v_dot2_f32_bf16 v24, v70, v21, v24
    v_dot2_f32_bf16 v24, v71, v21, v24
    v_dot2_f32_bf16 v25, v72, v21, 0
    v_dot2_f32_bf16 v25, v73, v21, v25
    v_dot2_f32_bf16 v25, v74, v21, v25
    v_dot2_f32_bf16 v25, v75, v21, v25
    v_dot2_f32_bf16 v26, v76, v21, 0
    v_dot2_f32_bf16 v26, v77, v21, v26
    v_dot2_f32_bf16 v26, v78, v21, v26
    v_dot2_f32_bf16 v26, v79, v21, v26
    v_dot2_f32_bf16 v27, v80, v21, 0
    v_dot2_f32_bf16 v27, v81, v21, v27
    v_dot2_f32_bf16 v27, v82, v21, v27
    v_dot2_f32_bf16 v27, v83, v21, v27
    v_dot2_f32_bf16 v28, v84, v21, 0
    v_dot2_f32_bf16 v28, v85, v21, v28
    v_dot2_f32_bf16 v28, v86, v21, v28
    v_dot2_f32_bf16 v28, v87, v21, v28
    v_dot2_f32_bf16 v29, v88, v21, 0
    v_dot2_f32_bf16 v29, v89, v21, v29
    v_dot2_f32_bf16 v29, v90, v21, v29
    v_dot2_f32_bf16 v29, v91, v21, v29
Lmcs_47:
    s_waitcnt lgkmcnt(0)
    v_mfma_f32_32x32x16_bf16 v[128:143], v[36:39], v[32:35], v[128:143]
    ds_read_b128 v[64:67], v2
    ds_read_b64_tr_b16 v[68:69], v5 offset:2048
    ds_read_b64_tr_b16 v[70:71], v5 offset:2560
    v_mfma_f32_32x32x16_bf16 v[144:159], v[40:43], v[32:35], v[144:159]
    ds_read_b64_tr_b16 v[72:73], v6 offset:2048
    ds_read_b64_tr_b16 v[74:75], v6 offset:2560
    ds_read_b64_tr_b16 v[76:77], v5 offset:10240
    v_mfma_f32_32x32x16_bf16 v[160:175], v[44:47], v[32:35], v[160:175]
    ds_read_b64_tr_b16 v[78:79], v5 offset:10752
    ds_read_b64_tr_b16 v[80:81], v6 offset:10240
    ds_read_b64_tr_b16 v[82:83], v6 offset:10752
    v_mfma_f32_32x32x16_bf16 v[176:191], v[48:51], v[32:35], v[176:191]
    ds_read_b64_tr_b16 v[84:85], v5 offset:18432
    ds_read_b64_tr_b16 v[86:87], v5 offset:18944
    ds_read_b64_tr_b16 v[88:89], v6 offset:18432
    v_mfma_f32_32x32x16_bf16 v[192:207], v[52:55], v[32:35], v[192:207]
    ds_read_b64_tr_b16 v[90:91], v6 offset:18944
    v_mfma_f32_32x32x16_bf16 v[208:223], v[56:59], v[32:35], v[208:223]
    s_and_b32 s13, s78, 1
    s_cbranch_scc0 Lmcs_48
    s_cmp_eq_u32 s8, 0
    s_cbranch_scc0 Lmcs_48
    v_dot2_f32_bf16 v24, v36, v21, v24
    v_dot2_f32_bf16 v24, v37, v21, v24
    v_dot2_f32_bf16 v24, v38, v21, v24
    v_dot2_f32_bf16 v24, v39, v21, v24
    v_dot2_f32_bf16 v25, v40, v21, v25
    v_dot2_f32_bf16 v25, v41, v21, v25
    v_dot2_f32_bf16 v25, v42, v21, v25
    v_dot2_f32_bf16 v25, v43, v21, v25
    v_dot2_f32_bf16 v26, v44, v21, v26
    v_dot2_f32_bf16 v26, v45, v21, v26
    v_dot2_f32_bf16 v26, v46, v21, v26
    v_dot2_f32_bf16 v26, v47, v21, v26
    v_dot2_f32_bf16 v27, v48, v21, v27
    v_dot2_f32_bf16 v27, v49, v21, v27
    v_dot2_f32_bf16 v27, v50, v21, v27
    v_dot2_f32_bf16 v27, v51, v21, v27
    v_dot2_f32_bf16 v28, v52, v21, v28
    v_dot2_f32_bf16 v28, v53, v21, v28
    v_dot2_f32_bf16 v28, v54, v21, v28
    v_dot2_f32_bf16 v28, v55, v21, v28
    v_dot2_f32_bf16 v29, v56, v21, v29
    v_dot2_f32_bf16 v29, v57, v21, v29
    v_dot2_f32_bf16 v29, v58, v21, v29
    v_dot2_f32_bf16 v29, v59, v21, v29
    s_nop 2
    ds_write_b32 v20, v24 offset:0
    ds_write_b32 v20, v25 offset:128
    ds_write_b32 v20, v26 offset:256
    ds_write_b32 v20, v27 offset:384
    ds_write_b32 v20, v28 offset:512
    ds_write_b32 v20, v29 offset:640
    s_lshl_b32 s13, s8, 2
    s_add_u32 s13, s13, 163680
    v_mov_b32 v14, s13
    v_mov_b32 v15, 1
    ds_write_b32 v14, v15
Lmcs_48:
    s_waitcnt lgkmcnt(0)
    v_mfma_f32_32x32x16_bf16 v[128:143], v[68:71], v[64:67], v[128:143]
    ds_read_b128 v[32:35], v3
    ds_read_b64_tr_b16 v[36:37], v5 offset:4096
    ds_read_b64_tr_b16 v[38:39], v5 offset:4608
    v_mfma_f32_32x32x16_bf16 v[144:159], v[72:75], v[64:67], v[144:159]
    ds_read_b64_tr_b16 v[40:41], v6 offset:4096
    ds_read_b64_tr_b16 v[42:43], v6 offset:4608
    ds_read_b64_tr_b16 v[44:45], v5 offset:12288
    v_mfma_f32_32x32x16_bf16 v[160:175], v[76:79], v[64:67], v[160:175]
    ds_read_b64_tr_b16 v[46:47], v5 offset:12800
    ds_read_b64_tr_b16 v[48:49], v6 offset:12288
    ds_read_b64_tr_b16 v[50:51], v6 offset:12800
    v_mfma_f32_32x32x16_bf16 v[176:191], v[80:83], v[64:67], v[176:191]
    ds_read_b64_tr_b16 v[52:53], v5 offset:20480
    ds_read_b64_tr_b16 v[54:55], v5 offset:20992
    ds_read_b64_tr_b16 v[56:57], v6 offset:20480
    v_mfma_f32_32x32x16_bf16 v[192:207], v[84:87], v[64:67], v[192:207]
    ds_read_b64_tr_b16 v[58:59], v6 offset:20992
    v_mfma_f32_32x32x16_bf16 v[208:223], v[88:91], v[64:67], v[208:223]
    s_and_b32 s13, s78, 1
    s_cbranch_scc0 Lmcs_49
    s_cmp_eq_u32 s8, 1
    s_cbranch_scc0 Lmcs_49
    v_dot2_f32_bf16 v24, v68, v21, v24
    v_dot2_f32_bf16 v24, v69, v21, v24
    v_dot2_f32_bf16 v24, v70, v21, v24
    v_dot2_f32_bf16 v24, v71, v21, v24
    v_dot2_f32_bf16 v25, v72, v21, v25
    v_dot2_f32_bf16 v25, v73, v21, v25
    v_dot2_f32_bf16 v25, v74, v21, v25
    v_dot2_f32_bf16 v25, v75, v21, v25
    v_dot2_f32_bf16 v26, v76, v21, v26
    v_dot2_f32_bf16 v26, v77, v21, v26
    v_dot2_f32_bf16 v26, v78, v21, v26
    v_dot2_f32_bf16 v26, v79, v21, v26
    v_dot2_f32_bf16 v27, v80, v21, v27
    v_dot2_f32_bf16 v27, v81, v21, v27
    v_dot2_f32_bf16 v27, v82, v21, v27
    v_dot2_f32_bf16 v27, v83, v21, v27
    v_dot2_f32_bf16 v28, v84, v21, v28
    v_dot2_f32_bf16 v28, v85, v21, v28
    v_dot2_f32_bf16 v28, v86, v21, v28
    v_dot2_f32_bf16 v28, v87, v21, v28
    v_dot2_f32_bf16 v29, v88, v21, v29
    v_dot2_f32_bf16 v29, v89, v21, v29
    v_dot2_f32_bf16 v29, v90, v21, v29
    v_dot2_f32_bf16 v29, v91, v21, v29
    s_nop 2
    ds_write_b32 v20, v24 offset:0
    ds_write_b32 v20, v25 offset:128
    ds_write_b32 v20, v26 offset:256
    ds_write_b32 v20, v27 offset:384
    ds_write_b32 v20, v28 offset:512
    ds_write_b32 v20, v29 offset:640
    s_lshl_b32 s13, s8, 2
    s_add_u32 s13, s13, 163680
    v_mov_b32 v14, s13
    v_mov_b32 v15, 1
    ds_write_b32 v14, v15
Lmcs_49:
    s_waitcnt lgkmcnt(0)
    v_mfma_f32_32x32x16_bf16 v[128:143], v[36:39], v[32:35], v[128:143]
    ds_read_b128 v[64:67], v4
    ds_read_b64_tr_b16 v[68:69], v5 offset:6144
    ds_read_b64_tr_b16 v[70:71], v5 offset:6656
    v_mfma_f32_32x32x16_bf16 v[144:159], v[40:43], v[32:35], v[144:159]
    ds_read_b64_tr_b16 v[72:73], v6 offset:6144
    ds_read_b64_tr_b16 v[74:75], v6 offset:6656
    ds_read_b64_tr_b16 v[76:77], v5 offset:14336
    v_mfma_f32_32x32x16_bf16 v[160:175], v[44:47], v[32:35], v[160:175]
    ds_read_b64_tr_b16 v[78:79], v5 offset:14848
    ds_read_b64_tr_b16 v[80:81], v6 offset:14336
    ds_read_b64_tr_b16 v[82:83], v6 offset:14848
    v_mfma_f32_32x32x16_bf16 v[176:191], v[48:51], v[32:35], v[176:191]
    ds_read_b64_tr_b16 v[84:85], v5 offset:22528
    ds_read_b64_tr_b16 v[86:87], v5 offset:23040
    ds_read_b64_tr_b16 v[88:89], v6 offset:22528
    v_mfma_f32_32x32x16_bf16 v[192:207], v[52:55], v[32:35], v[192:207]
    ds_read_b64_tr_b16 v[90:91], v6 offset:23040
    v_mfma_f32_32x32x16_bf16 v[208:223], v[56:59], v[32:35], v[208:223]
    s_and_b32 s13, s78, 1
    s_cbranch_scc0 Lmcs_50
    s_cmp_eq_u32 s8, 2
    s_cbranch_scc0 Lmcs_50
    v_dot2_f32_bf16 v24, v36, v21, v24
    v_dot2_f32_bf16 v24, v37, v21, v24
    v_dot2_f32_bf16 v24, v38, v21, v24
    v_dot2_f32_bf16 v24, v39, v21, v24
    v_dot2_f32_bf16 v25, v40, v21, v25
    v_dot2_f32_bf16 v25, v41, v21, v25
    v_dot2_f32_bf16 v25, v42, v21, v25
    v_dot2_f32_bf16 v25, v43, v21, v25
    v_dot2_f32_bf16 v26, v44, v21, v26
    v_dot2_f32_bf16 v26, v45, v21, v26
    v_dot2_f32_bf16 v26, v46, v21, v26
    v_dot2_f32_bf16 v26, v47, v21, v26
    v_dot2_f32_bf16 v27, v48, v21, v27
    v_dot2_f32_bf16 v27, v49, v21, v27
    v_dot2_f32_bf16 v27, v50, v21, v27
    v_dot2_f32_bf16 v27, v51, v21, v27
    v_dot2_f32_bf16 v28, v52, v21, v28
    v_dot2_f32_bf16 v28, v53, v21, v28
    v_dot2_f32_bf16 v28, v54, v21, v28
    v_dot2_f32_bf16 v28, v55, v21, v28
    v_dot2_f32_bf16 v29, v56, v21, v29
    v_dot2_f32_bf16 v29, v57, v21, v29
    v_dot2_f32_bf16 v29, v58, v21, v29
    v_dot2_f32_bf16 v29, v59, v21, v29
    s_nop 2
    ds_write_b32 v20, v24 offset:0
    ds_write_b32 v20, v25 offset:128
    ds_write_b32 v20, v26 offset:256
    ds_write_b32 v20, v27 offset:384
    ds_write_b32 v20, v28 offset:512
    ds_write_b32 v20, v29 offset:640
    s_lshl_b32 s13, s8, 2
    s_add_u32 s13, s13, 163680
    v_mov_b32 v14, s13
    v_mov_b32 v15, 1
    ds_write_b32 v14, v15
Lmcs_50:
    s_waitcnt lgkmcnt(0)
    v_mfma_f32_32x32x16_bf16 v[128:143], v[68:71], v[64:67], v[128:143]
    s_barrier
    s_add_u32 s60, s60, 43008
    s_cmp_eq_u32 s60, 129024
    s_cselect_b32 s60, 0, s60
    v_mfma_f32_32x32x16_bf16 v[144:159], v[72:75], v[64:67], v[144:159]
    v_add_u32 v1, s60, v8
    v_add_u32 v2, s60, v9
    v_add_u32 v3, s60, v10
    v_add_u32 v4, s60, v11
    v_add_u32 v5, s60, v12
    v_add_u32 v6, s60, v13
    v_mfma_f32_32x32x16_bf16 v[160:175], v[76:79], v[64:67], v[160:175]
    ds_read_b128 v[32:35], v1
    ds_read_b64_tr_b16 v[36:37], v5 offset:0
    ds_read_b64_tr_b16 v[38:39], v5 offset:512
    ds_read_b64_tr_b16 v[40:41], v6 offset:0
    v_mfma_f32_32x32x16_bf16 v[176:191], v[80:83], v[64:67], v[176:191]
    ds_read_b64_tr_b16 v[42:43], v6 offset:512
    ds_read_b64_tr_b16 v[44:45], v5 offset:8192
    ds_read_b64_tr_b16 v[46:47], v5 offset:8704
    ds_read_b64_tr_b16 v[48:49], v6 offset:8192
    v_mfma_f32_32x32x16_bf16 v[192:207], v[84:87], v[64:67], v[192:207]
    ds_read_b64_tr_b16 v[50:51], v6 offset:8704
    ds_read_b64_tr_b16 v[52:53], v5 offset:16384
    ds_read_b64_tr_b16 v[54:55], v5 offset:16896
    ds_read_b64_tr_b16 v[56:57], v6 offset:16384
    v_mfma_f32_32x32x16_bf16 v[208:223], v[88:91], v[64:67], v[208:223]
    ds_read_b64_tr_b16 v[58:59], v6 offset:16896
    s_and_b32 s13, s78, 1
    s_cbranch_scc0 Lmcs_51
    s_cmp_eq_u32 s8, 3
    s_cbranch_scc0 Lmcs_51
    v_dot2_f32_bf16 v24, v68, v21, v24
    v_dot2_f32_bf16 v24, v69, v21, v24
    v_dot2_f32_bf16 v24, v70, v21, v24
    v_dot2_f32_bf16 v24, v71, v21, v24
    v_dot2_f32_bf16 v25, v72, v21, v25
    v_dot2_f32_bf16 v25, v73, v21, v25
    v_dot2_f32_bf16 v25, v74, v21, v25
    v_dot2_f32_bf16 v25, v75, v21, v25
    v_dot2_f32_bf16 v26, v76, v21, v26
    v_dot2_f32_bf16 v26, v77, v21, v26
    v_dot2_f32_bf16 v26, v78, v21, v26
    v_dot2_f32_bf16 v26, v79, v21, v26
    v_dot2_f32_bf16 v27, v80, v21, v27
    v_dot2_f32_bf16 v27, v81, v21, v27
    v_dot2_f32_bf16 v27, v82, v21, v27
    v_dot2_f32_bf16 v27, v83, v21, v27
    v_dot2_f32_bf16 v28, v84, v21, v28
    v_dot2_f32_bf16 v28, v85, v21, v28
    v_dot2_f32_bf16 v28, v86, v21, v28
    v_dot2_f32_bf16 v28, v87, v21, v28
    v_dot2_f32_bf16 v29, v88, v21, v29
    v_dot2_f32_bf16 v29, v89, v21, v29
    v_dot2_f32_bf16 v29, v90, v21, v29
    v_dot2_f32_bf16 v29, v91, v21, v29
    s_nop 2
    ds_write_b32 v20, v24 offset:0
    ds_write_b32 v20, v25 offset:128
    ds_write_b32 v20, v26 offset:256
    ds_write_b32 v20, v27 offset:384
    ds_write_b32 v20, v28 offset:512
    ds_write_b32 v20, v29 offset:640
    s_lshl_b32 s13, s8, 2
    s_add_u32 s13, s13, 163680
    v_mov_b32 v14, s13
    v_mov_b32 v15, 1
    ds_write_b32 v14, v15
Lmcs_51:
    s_mov_b32 s63, 6
.p2align 6
Lmloop_52:
    s_waitcnt lgkmcnt(0)
    v_mfma_f32_32x32x16_bf16 v[128:143], v[36:39], v[32:35], v[128:143]
    ds_read_b128 v[64:67], v2
    ds_read_b64_tr_b16 v[68:69], v5 offset:2048
    ds_read_b64_tr_b16 v[70:71], v5 offset:2560
    v_mfma_f32_32x32x16_bf16 v[144:159], v[40:43], v[32:35], v[144:159]
    ds_read_b64_tr_b16 v[72:73], v6 offset:2048
    ds_read_b64_tr_b16 v[74:75], v6 offset:2560
    ds_read_b64_tr_b16 v[76:77], v5 offset:10240
    v_mfma_f32_32x32x16_bf16 v[160:175], v[44:47], v[32:35], v[160:175]
    ds_read_b64_tr_b16 v[78:79], v5 offset:10752
    ds_read_b64_tr_b16 v[80:81], v6 offset:10240
    ds_read_b64_tr_b16 v[82:83], v6 offset:10752
    v_mfma_f32_32x32x16_bf16 v[176:191], v[48:51], v[32:35], v[176:191]
    ds_read_b64_tr_b16 v[84:85], v5 offset:18432
    ds_read_b64_tr_b16 v[86:87], v5 offset:18944
    ds_read_b64_tr_b16 v[88:89], v6 offset:18432
    v_mfma_f32_32x32x16_bf16 v[192:207], v[52:55], v[32:35], v[192:207]
    ds_read_b64_tr_b16 v[90:91], v6 offset:18944
    v_mfma_f32_32x32x16_bf16 v[208:223], v[56:59], v[32:35], v[208:223]
    s_waitcnt lgkmcnt(0)
    v_mfma_f32_32x32x16_bf16 v[128:143], v[68:71], v[64:67], v[128:143]
    ds_read_b128 v[32:35], v3
    ds_read_b64_tr_b16 v[36:37], v5 offset:4096
    ds_read_b64_tr_b16 v[38:39], v5 offset:4608
    v_mfma_f32_32x32x16_bf16 v[144:159], v[72:75], v[64:67], v[144:159]
    ds_read_b64_tr_b16 v[40:41], v6 offset:4096
    ds_read_b64_tr_b16 v[42:43], v6 offset:4608
    ds_read_b64_tr_b16 v[44:45], v5 offset:12288
    v_mfma_f32_32x32x16_bf16 v[160:175], v[76:79], v[64:67], v[160:175]
    ds_read_b64_tr_b16 v[46:47], v5 offset:12800
    ds_read_b64_tr_b16 v[48:49], v6 offset:12288
    ds_read_b64_tr_b16 v[50:51], v6 offset:12800
    v_mfma_f32_32x32x16_bf16 v[176:191], v[80:83], v[64:67], v[176:191]
    ds_read_b64_tr_b16 v[52:53], v5 offset:20480
    ds_read_b64_tr_b16 v[54:55], v5 offset:20992
    ds_read_b64_tr_b16 v[56:57], v6 offset:20480
    v_mfma_f32_32x32x16_bf16 v[192:207], v[84:87], v[64:67], v[192:207]
    ds_read_b64_tr_b16 v[58:59], v6 offset:20992
    v_mfma_f32_32x32x16_bf16 v[208:223], v[88:91], v[64:67], v[208:223]
    s_waitcnt lgkmcnt(0)
    v_mfma_f32_32x32x16_bf16 v[128:143], v[36:39], v[32:35], v[128:143]
    ds_read_b128 v[64:67], v4
    ds_read_b64_tr_b16 v[68:69], v5 offset:6144
    ds_read_b64_tr_b16 v[70:71], v5 offset:6656
    v_mfma_f32_32x32x16_bf16 v[144:159], v[40:43], v[32:35], v[144:159]
    ds_read_b64_tr_b16 v[72:73], v6 offset:6144
    ds_read_b64_tr_b16 v[74:75], v6 offset:6656
    ds_read_b64_tr_b16 v[76:77], v5 offset:14336
    v_mfma_f32_32x32x16_bf16 v[160:175], v[44:47], v[32:35], v[160:175]
    ds_read_b64_tr_b16 v[78:79], v5 offset:14848
    ds_read_b64_tr_b16 v[80:81], v6 offset:14336
    ds_read_b64_tr_b16 v[82:83], v6 offset:14848
    v_mfma_f32_32x32x16_bf16 v[176:191], v[48:51], v[32:35], v[176:191]
    ds_read_b64_tr_b16 v[84:85], v5 offset:22528
    ds_read_b64_tr_b16 v[86:87], v5 offset:23040
    ds_read_b64_tr_b16 v[88:89], v6 offset:22528
    v_mfma_f32_32x32x16_bf16 v[192:207], v[52:55], v[32:35], v[192:207]
    ds_read_b64_tr_b16 v[90:91], v6 offset:23040
    v_mfma_f32_32x32x16_bf16 v[208:223], v[56:59], v[32:35], v[208:223]
    s_waitcnt lgkmcnt(0)
    v_mfma_f32_32x32x16_bf16 v[128:143], v[68:71], v[64:67], v[128:143]
    s_barrier
    s_add_u32 s60, s60, 43008
    s_cmp_eq_u32 s60, 129024
    s_cselect_b32 s60, 0, s60
    v_mfma_f32_32x32x16_bf16 v[144:159], v[72:75], v[64:67], v[144:159]
    v_add_u32 v1, s60, v8
    v_add_u32 v2, s60, v9
    v_add_u32 v3, s60, v10
    v_add_u32 v4, s60, v11
    v_add_u32 v5, s60, v12
    v_add_u32 v6, s60, v13
    v_mfma_f32_32x32x16_bf16 v[160:175], v[76:79], v[64:67], v[160:175]
    ds_read_b128 v[32:35], v1
    ds_read_b64_tr_b16 v[36:37], v5 offset:0
    ds_read_b64_tr_b16 v[38:39], v5 offset:512
    ds_read_b64_tr_b16 v[40:41], v6 offset:0
    v_mfma_f32_32x32x16_bf16 v[176:191], v[80:83], v[64:67], v[176:191]
    ds_read_b64_tr_b16 v[42:43], v6 offset:512
    ds_read_b64_tr_b16 v[44:45], v5 offset:8192
    ds_read_b64_tr_b16 v[46:47], v5 offset:8704
    ds_read_b64_tr_b16 v[48:49], v6 offset:8192
    v_mfma_f32_32x32x16_bf16 v[192:207], v[84:87], v[64:67], v[192:207]
    ds_read_b64_tr_b16 v[50:51], v6 offset:8704
    ds_read_b64_tr_b16 v[52:53], v5 offset:16384
    ds_read_b64_tr_b16 v[54:55], v5 offset:16896
    ds_read_b64_tr_b16 v[56:57], v6 offset:16384
    v_mfma_f32_32x32x16_bf16 v[208:223], v[88:91], v[64:67], v[208:223]
    ds_read_b64_tr_b16 v[58:59], v6 offset:16896
    s_sub_u32 s63, s63, 1
    s_cmp_lg_u32 s63, 0
    s_cbranch_scc1 Lmloop_52
    s_waitcnt lgkmcnt(0)
    s_waitcnt vmcnt(0)
    v_mov_b32 v14, 163648
    s_mov_b32 s95, 0
Lwst_53:
    ds_read_b32 v15, v14
    ds_read_b32 v8, v14 offset:4
    ds_read_b32 v9, v14 offset:8
    s_waitcnt lgkmcnt(0)
    v_add3_u32 v15, v15, v8, v9
    s_nop 0
    v_readfirstlane_b32 s94, v15
    s_nop 0
    s_cmp_eq_u32 s94, 3
    s_cbranch_scc1 Lwsd_54
    s_add_u32 s95, s95, 1
    s_cmp_gt_u32 s95, 8388608
    s_cbranch_scc1 Lwsd_54
    s_sleep 1
    s_branch Lwst_53
Lwsd_54:
    v_and_b32 v14, 31, v0
    v_lshrrev_b32 v15, 5, v0
    s_lshl_b32 s13, s8, 5
    s_add_u32 s13, s13, 16
    v_add_u32 v16, s13, v14
    v_lshlrev_b32 v16, 3, v16
    v_add_u32 v16, 155648, v16
    ds_read_b64 v[2:3], v16
    v_lshlrev_b32 v17, 5, v15
    v_add_u32 v17, 157952, v17
    v_mov_b32 v4, 0xc0135761
    v_mov_b32 v5, 0xc0135761
    v_mov_b32 v20, 1.0
    v_mov_b32 v21, 1.0
    s_mov_b32 s68, 0xbdd2d3e8
    s_mov_b32 s69, 0xbdd2d3e8
    s_lshl_b32 s13, s9, 2
    s_add_u32 s13, s13, s8
    s_mul_i32 s13, s13, 118
    s_lshl_b32 s14, s12, 1
    s_add_u32 s13, s13, s14
    s_add_u32 s13, s13, 32
    s_lshl_b32 s13, s13, 10
    v_lshlrev_b32 v18, 4, v0
    v_add_u32 v18, s13, v18
    ds_read_b128 v[32:35], v17 offset:0
    ds_read_b128 v[48:51], v17 offset:768
    ds_read_b128 v[36:39], v17 offset:16
    ds_read_b128 v[52:55], v17 offset:784
    ds_read_b128 v[40:43], v17 offset:64
    ds_read_b128 v[56:59], v17 offset:832
    ds_read_b128 v[44:47], v17 offset:80
    ds_read_b128 v[60:63], v17 offset:848
    ds_read_b128 v[64:67], v17 offset:128
    ds_read_b128 v[80:83], v17 offset:896
    ds_read_b128 v[68:71], v17 offset:144
    ds_read_b128 v[84:87], v17 offset:912
    ds_read_b128 v[72:75], v17 offset:192
    ds_read_b128 v[88:91], v17 offset:960
    ds_read_b128 v[76:79], v17 offset:208
    ds_read_b128 v[92:95], v17 offset:976
    s_waitcnt lgkmcnt(14)
    v_pk_fma_f32 v[112:113], v[32:33], v[2:3], v[48:49] op_sel:[0,1,0] op_sel_hi:[1,1,1] neg_lo:[0,1,0] neg_hi:[0,1,0]
    v_pk_fma_f32 v[114:115], v[34:35], v[2:3], v[50:51] op_sel:[0,1,0] op_sel_hi:[1,1,1] neg_lo:[0,1,0] neg_hi:[0,1,0]
    s_waitcnt lgkmcnt(12)
    v_pk_fma_f32 v[116:117], v[36:37], v[2:3], v[52:53] op_sel:[0,1,0] op_sel_hi:[1,1,1] neg_lo:[0,1,0] neg_hi:[0,1,0]
    v_pk_fma_f32 v[118:119], v[38:39], v[2:3], v[54:55] op_sel:[0,1,0] op_sel_hi:[1,1,1] neg_lo:[0,1,0] neg_hi:[0,1,0]
    s_waitcnt lgkmcnt(10)
    v_pk_fma_f32 v[120:121], v[40:41], v[2:3], v[56:57] op_sel:[0,1,0] op_sel_hi:[1,1,1] neg_lo:[0,1,0] neg_hi:[0,1,0]
    v_pk_fma_f32 v[122:123], v[42:43], v[2:3], v[58:59] op_sel:[0,1,0] op_sel_hi:[1,1,1] neg_lo:[0,1,0] neg_hi:[0,1,0]
    s_waitcnt lgkmcnt(8)
    v_pk_fma_f32 v[124:125], v[44:45], v[2:3], v[60:61] op_sel:[0,1,0] op_sel_hi:[1,1,1] neg_lo:[0,1,0] neg_hi:[0,1,0]
    v_pk_fma_f32 v[126:127], v[46:47], v[2:3], v[62:63] op_sel:[0,1,0] op_sel_hi:[1,1,1] neg_lo:[0,1,0] neg_hi:[0,1,0]
    v_pk_fma_f32 v[128:129], v[128:129], v[2:3], v[112:113] op_sel_hi:[1,0,1]
    v_pk_fma_f32 v[130:131], v[130:131], v[2:3], v[114:115] op_sel_hi:[1,0,1]
    v_pk_fma_f32 v[132:133], v[132:133], v[2:3], v[116:117] op_sel_hi:[1,0,1]
    v_pk_fma_f32 v[134:135], v[134:135], v[2:3], v[118:119] op_sel_hi:[1,0,1]
    v_pk_fma_f32 v[136:137], v[136:137], v[2:3], v[120:121] op_sel_hi:[1,0,1]
    v_pk_fma_f32 v[138:139], v[138:139], v[2:3], v[122:123] op_sel_hi:[1,0,1]
    v_pk_fma_f32 v[140:141], v[140:141], v[2:3], v[124:125] op_sel_hi:[1,0,1]
    v_pk_fma_f32 v[142:143], v[142:143], v[2:3], v[126:127] op_sel_hi:[1,0,1]
    v_pk_mul_f32 v[112:113], v[128:129], v[128:129]
    v_pk_mul_f32 v[114:115], v[130:131], v[130:131]
    v_pk_mul_f32 v[116:117], v[132:133], v[132:133]
    v_pk_mul_f32 v[118:119], v[134:135], v[134:135]
    v_pk_mul_f32 v[120:121], v[136:137], v[136:137]
    v_pk_mul_f32 v[122:123], v[138:139], v[138:139]
    v_pk_mul_f32 v[124:125], v[140:141], v[140:141]
    v_pk_mul_f32 v[126:127], v[142:143], v[142:143]
    v_pk_fma_f32 v[112:113], v[112:113], s[68:69], v[4:5]
    v_pk_fma_f32 v[114:115], v[114:115], s[68:69], v[4:5]
    v_pk_fma_f32 v[116:117], v[116:117], s[68:69], v[4:5]
    v_pk_fma_f32 v[118:119], v[118:119], s[68:69], v[4:5]
    v_pk_fma_f32 v[120:121], v[120:121], s[68:69], v[4:5]
    v_pk_fma_f32 v[122:123], v[122:123], s[68:69], v[4:5]
    v_pk_fma_f32 v[124:125], v[124:125], s[68:69], v[4:5]
    v_pk_fma_f32 v[126:127], v[126:127], s[68:69], v[4:5]
    v_pk_mul_f32 v[112:113], v[112:113], v[128:129]
    v_pk_mul_f32 v[114:115], v[114:115], v[130:131]
    v_pk_mul_f32 v[116:117], v[116:117], v[132:133]
    v_pk_mul_f32 v[118:119], v[118:119], v[134:135]
    v_pk_mul_f32 v[120:121], v[120:121], v[136:137]
    v_pk_mul_f32 v[122:123], v[122:123], v[138:139]
    v_pk_mul_f32 v[124:125], v[124:125], v[140:141]
    v_pk_mul_f32 v[126:127], v[126:127], v[142:143]
    v_exp_f32 v112, v112
    v_exp_f32 v114, v114
    v_exp_f32 v116, v116
    v_exp_f32 v118, v118
    v_exp_f32 v120, v120
    v_exp_f32 v122, v122
    v_exp_f32 v124, v124
    v_exp_f32 v126, v126
    v_exp_f32 v113, v113
    v_exp_f32 v115, v115
    v_exp_f32 v117, v117
    v_exp_f32 v119, v119
    v_exp_f32 v121, v121
    v_exp_f32 v123, v123
    v_exp_f32 v125, v125
    v_exp_f32 v127, v127
    v_pk_add_f32 v[112:113], v[112:113], v[20:21]
    v_pk_add_f32 v[114:115], v[114:115], v[20:21]
    v_pk_add_f32 v[116:117], v[116:117], v[20:21]
    v_pk_add_f32 v[118:119], v[118:119], v[20:21]
    v_pk_add_f32 v[120:121], v[120:121], v[20:21]
    v_pk_add_f32 v[122:123], v[122:123], v[20:21]
    v_pk_add_f32 v[124:125], v[124:125], v[20:21]
    v_pk_add_f32 v[126:127], v[126:127], v[20:21]
    v_rcp_f32 v112, v112
    v_rcp_f32 v114, v114
    v_rcp_f32 v116, v116
    v_rcp_f32 v118, v118
    v_rcp_f32 v120, v120
    v_rcp_f32 v122, v122
    v_rcp_f32 v124, v124
    v_rcp_f32 v126, v126
    v_rcp_f32 v113, v113
    v_rcp_f32 v115, v115
    v_rcp_f32 v117, v117
    v_rcp_f32 v119, v119
    v_rcp_f32 v121, v121
    v_rcp_f32 v123, v123
    v_rcp_f32 v125, v125
    v_rcp_f32 v127, v127
    v_pk_mul_f32 v[112:113], v[112:113], v[128:129]
    v_pk_mul_f32 v[114:115], v[114:115], v[130:131]
    v_pk_mul_f32 v[116:117], v[116:117], v[132:133]
    v_pk_mul_f32 v[118:119], v[118:119], v[134:135]
    v_pk_mul_f32 v[120:121], v[120:121], v[136:137]
    v_pk_mul_f32 v[122:123], v[122:123], v[138:139]
    v_pk_mul_f32 v[124:125], v[124:125], v[140:141]
    v_pk_mul_f32 v[126:127], v[126:127], v[142:143]
    v_cvt_pk_bf16_f32 v96, v112, v113
    v_cvt_pk_bf16_f32 v102, v124, v125
    v_cvt_pk_bf16_f32 v97, v114, v115
    v_cvt_pk_bf16_f32 v99, v118, v119
    v_cvt_pk_bf16_f32 v98, v116, v117
    v_cvt_pk_bf16_f32 v100, v120, v121
    v_cvt_pk_bf16_f32 v101, v122, v123
    v_cvt_pk_bf16_f32 v103, v126, v127
    global_store_dwordx4 v18, v[96:99], s[36:37] sc1
    global_store_dwordx4 v18, v[100:103], s[36:37] offset:1024 sc1
    s_nop 1
    v_add_u32 v18, 2048, v18
    ds_read_b128 v[32:35], v17 offset:256
    ds_read_b128 v[48:51], v17 offset:1024
    ds_read_b128 v[36:39], v17 offset:272
    ds_read_b128 v[52:55], v17 offset:1040
    ds_read_b128 v[40:43], v17 offset:320
    ds_read_b128 v[56:59], v17 offset:1088
    ds_read_b128 v[44:47], v17 offset:336
    ds_read_b128 v[60:63], v17 offset:1104
    s_waitcnt lgkmcnt(14)
    v_pk_fma_f32 v[112:113], v[64:65], v[2:3], v[80:81] op_sel:[0,1,0] op_sel_hi:[1,1,1] neg_lo:[0,1,0] neg_hi:[0,1,0]
    v_pk_fma_f32 v[114:115], v[66:67], v[2:3], v[82:83] op_sel:[0,1,0] op_sel_hi:[1,1,1] neg_lo:[0,1,0] neg_hi:[0,1,0]
    s_waitcnt lgkmcnt(12)
    v_pk_fma_f32 v[116:117], v[68:69], v[2:3], v[84:85] op_sel:[0,1,0] op_sel_hi:[1,1,1] neg_lo:[0,1,0] neg_hi:[0,1,0]
    v_pk_fma_f32 v[118:119], v[70:71], v[2:3], v[86:87] op_sel:[0,1,0] op_sel_hi:[1,1,1] neg_lo:[0,1,0] neg_hi:[0,1,0]
    s_waitcnt lgkmcnt(10)
    v_pk_fma_f32 v[120:121], v[72:73], v[2:3], v[88:89] op_sel:[0,1,0] op_sel_hi:[1,1,1] neg_lo:[0,1,0] neg_hi:[0,1,0]
    v_pk_fma_f32 v[122:123], v[74:75], v[2:3], v[90:91] op_sel:[0,1,0] op_sel_hi:[1,1,1] neg_lo:[0,1,0] neg_hi:[0,1,0]
    s_waitcnt lgkmcnt(8)
    v_pk_fma_f32 v[124:125], v[76:77], v[2:3], v[92:93] op_sel:[0,1,0] op_sel_hi:[1,1,1] neg_lo:[0,1,0] neg_hi:[0,1,0]
    v_pk_fma_f32 v[126:127], v[78:79], v[2:3], v[94:95] op_sel:[0,1,0] op_sel_hi:[1,1,1] neg_lo:[0,1,0] neg_hi:[0,1,0]
    v_pk_fma_f32 v[144:145], v[144:145], v[2:3], v[112:113] op_sel_hi:[1,0,1]
    v_pk_fma_f32 v[146:147], v[146:147], v[2:3], v[114:115] op_sel_hi:[1,0,1]
    v_pk_fma_f32 v[148:149], v[148:149], v[2:3], v[116:117] op_sel_hi:[1,0,1]
    v_pk_fma_f32 v[150:151], v[150:151], v[2:3], v[118:119] op_sel_hi:[1,0,1]
    v_pk_fma_f32 v[152:153], v[152:153], v[2:3], v[120:121] op_sel_hi:[1,0,1]
    v_pk_fma_f32 v[154:155], v[154:155], v[2:3], v[122:123] op_sel_hi:[1,0,1]
    v_pk_fma_f32 v[156:157], v[156:157], v[2:3], v[124:125] op_sel_hi:[1,0,1]
    v_pk_fma_f32 v[158:159], v[158:159], v[2:3], v[126:127] op_sel_hi:[1,0,1]
    v_pk_mul_f32 v[112:113], v[144:145], v[144:145]
    v_pk_mul_f32 v[114:115], v[146:147], v[146:147]
    v_pk_mul_f32 v[116:117], v[148:149], v[148:149]
    v_pk_mul_f32 v[118:119], v[150:151], v[150:151]
    v_pk_mul_f32 v[120:121], v[152:153], v[152:153]
    v_pk_mul_f32 v[122:123], v[154:155], v[154:155]
    v_pk_mul_f32 v[124:125], v[156:157], v[156:157]
    v_pk_mul_f32 v[126:127], v[158:159], v[158:159]
    v_pk_fma_f32 v[112:113], v[112:113], s[68:69], v[4:5]
    v_pk_fma_f32 v[114:115], v[114:115], s[68:69], v[4:5]
    v_pk_fma_f32 v[116:117], v[116:117], s[68:69], v[4:5]
    v_pk_fma_f32 v[118:119], v[118:119], s[68:69], v[4:5]
    v_pk_fma_f32 v[120:121], v[120:121], s[68:69], v[4:5]
    v_pk_fma_f32 v[122:123], v[122:123], s[68:69], v[4:5]
    v_pk_fma_f32 v[124:125], v[124:125], s[68:69], v[4:5]
    v_pk_fma_f32 v[126:127], v[126:127], s[68:69], v[4:5]
    v_pk_mul_f32 v[112:113], v[112:113], v[144:145]
    v_pk_mul_f32 v[114:115], v[114:115], v[146:147]
    v_pk_mul_f32 v[116:117], v[116:117], v[148:149]
    v_pk_mul_f32 v[118:119], v[118:119], v[150:151]
    v_pk_mul_f32 v[120:121], v[120:121], v[152:153]
    v_pk_mul_f32 v[122:123], v[122:123], v[154:155]
    v_pk_mul_f32 v[124:125], v[124:125], v[156:157]
    v_pk_mul_f32 v[126:127], v[126:127], v[158:159]
    v_exp_f32 v112, v112
    v_exp_f32 v114, v114
    v_exp_f32 v116, v116
    v_exp_f32 v118, v118
    v_exp_f32 v120, v120
    v_exp_f32 v122, v122
    v_exp_f32 v124, v124
    v_exp_f32 v126, v126
    v_exp_f32 v113, v113
    v_exp_f32 v115, v115
    v_exp_f32 v117, v117
    v_exp_f32 v119, v119
    v_exp_f32 v121, v121
    v_exp_f32 v123, v123
    v_exp_f32 v125, v125
    v_exp_f32 v127, v127
    v_pk_add_f32 v[112:113], v[112:113], v[20:21]
    v_pk_add_f32 v[114:115], v[114:115], v[20:21]
    v_pk_add_f32 v[116:117], v[116:117], v[20:21]
    v_pk_add_f32 v[118:119], v[118:119], v[20:21]
    v_pk_add_f32 v[120:121], v[120:121], v[20:21]
    v_pk_add_f32 v[122:123], v[122:123], v[20:21]
    v_pk_add_f32 v[124:125], v[124:125], v[20:21]
    v_pk_add_f32 v[126:127], v[126:127], v[20:21]
    v_rcp_f32 v112, v112
    v_rcp_f32 v114, v114
    v_rcp_f32 v116, v116
    v_rcp_f32 v118, v118
    v_rcp_f32 v120, v120
    v_rcp_f32 v122, v122
    v_rcp_f32 v124, v124
    v_rcp_f32 v126, v126
    v_rcp_f32 v113, v113
    v_rcp_f32 v115, v115
    v_rcp_f32 v117, v117
    v_rcp_f32 v119, v119
    v_rcp_f32 v121, v121
    v_rcp_f32 v123, v123
    v_rcp_f32 v125, v125
    v_rcp_f32 v127, v127
    v_pk_mul_f32 v[112:113], v[112:113], v[144:145]
    v_pk_mul_f32 v[114:115], v[114:115], v[146:147]
    v_pk_mul_f32 v[116:117], v[116:117], v[148:149]
    v_pk_mul_f32 v[118:119], v[118:119], v[150:151]
    v_pk_mul_f32 v[120:121], v[120:121], v[152:153]
    v_pk_mul_f32 v[122:123], v[122:123], v[154:155]
    v_pk_mul_f32 v[124:125], v[124:125], v[156:157]
    v_pk_mul_f32 v[126:127], v[126:127], v[158:159]
    v_cvt_pk_bf16_f32 v104, v112, v113
    v_cvt_pk_bf16_f32 v110, v124, v125
    v_cvt_pk_bf16_f32 v105, v114, v115
    v_cvt_pk_bf16_f32 v107, v118, v119
    v_cvt_pk_bf16_f32 v106, v116, v117
    v_cvt_pk_bf16_f32 v108, v120, v121
    v_cvt_pk_bf16_f32 v109, v122, v123
    v_cvt_pk_bf16_f32 v111, v126, v127
    global_store_dwordx4 v18, v[104:107], s[36:37] sc1
    global_store_dwordx4 v18, v[108:111], s[36:37] offset:1024 sc1
    s_nop 1
    v_add_u32 v18, 2048, v18
    ds_read_b128 v[64:67], v17 offset:384
    ds_read_b128 v[80:83], v17 offset:1152
    ds_read_b128 v[68:71], v17 offset:400
    ds_read_b128 v[84:87], v17 offset:1168
    ds_read_b128 v[72:75], v17 offset:448
    ds_read_b128 v[88:91], v17 offset:1216
    ds_read_b128 v[76:79], v17 offset:464
    ds_read_b128 v[92:95], v17 offset:1232
    s_waitcnt lgkmcnt(14)
    v_pk_fma_f32 v[112:113], v[32:33], v[2:3], v[48:49] op_sel:[0,1,0] op_sel_hi:[1,1,1] neg_lo:[0,1,0] neg_hi:[0,1,0]
    v_pk_fma_f32 v[114:115], v[34:35], v[2:3], v[50:51] op_sel:[0,1,0] op_sel_hi:[1,1,1] neg_lo:[0,1,0] neg_hi:[0,1,0]
    s_waitcnt lgkmcnt(12)
    v_pk_fma_f32 v[116:117], v[36:37], v[2:3], v[52:53] op_sel:[0,1,0] op_sel_hi:[1,1,1] neg_lo:[0,1,0] neg_hi:[0,1,0]
    v_pk_fma_f32 v[118:119], v[38:39], v[2:3], v[54:55] op_sel:[0,1,0] op_sel_hi:[1,1,1] neg_lo:[0,1,0] neg_hi:[0,1,0]
    s_waitcnt lgkmcnt(10)
    v_pk_fma_f32 v[120:121], v[40:41], v[2:3], v[56:57] op_sel:[0,1,0] op_sel_hi:[1,1,1] neg_lo:[0,1,0] neg_hi:[0,1,0]
    v_pk_fma_f32 v[122:123], v[42:43], v[2:3], v[58:59] op_sel:[0,1,0] op_sel_hi:[1,1,1] neg_lo:[0,1,0] neg_hi:[0,1,0]
    s_waitcnt lgkmcnt(8)
    v_pk_fma_f32 v[124:125], v[44:45], v[2:3], v[60:61] op_sel:[0,1,0] op_sel_hi:[1,1,1] neg_lo:[0,1,0] neg_hi:[0,1,0]
    v_pk_fma_f32 v[126:127], v[46:47], v[2:3], v[62:63] op_sel:[0,1,0] op_sel_hi:[1,1,1] neg_lo:[0,1,0] neg_hi:[0,1,0]
    v_pk_fma_f32 v[160:161], v[160:161], v[2:3], v[112:113] op_sel_hi:[1,0,1]
    v_pk_fma_f32 v[162:163], v[162:163], v[2:3], v[114:115] op_sel_hi:[1,0,1]
    v_pk_fma_f32 v[164:165], v[164:165], v[2:3], v[116:117] op_sel_hi:[1,0,1]
    v_pk_fma_f32 v[166:167], v[166:167], v[2:3], v[118:119] op_sel_hi:[1,0,1]
    v_pk_fma_f32 v[168:169], v[168:169], v[2:3], v[120:121] op_sel_hi:[1,0,1]
    v_pk_fma_f32 v[170:171], v[170:171], v[2:3], v[122:123] op_sel_hi:[1,0,1]
    v_pk_fma_f32 v[172:173], v[172:173], v[2:3], v[124:125] op_sel_hi:[1,0,1]
    v_pk_fma_f32 v[174:175], v[174:175], v[2:3], v[126:127] op_sel_hi:[1,0,1]
    v_pk_mul_f32 v[112:113], v[160:161], v[160:161]
    v_pk_mul_f32 v[114:115], v[162:163], v[162:163]
    v_pk_mul_f32 v[116:117], v[164:165], v[164:165]
    v_pk_mul_f32 v[118:119], v[166:167], v[166:167]
    v_pk_mul_f32 v[120:121], v[168:169], v[168:169]
    v_pk_mul_f32 v[122:123], v[170:171], v[170:171]
    v_pk_mul_f32 v[124:125], v[172:173], v[172:173]
    v_pk_mul_f32 v[126:127], v[174:175], v[174:175]
    v_pk_fma_f32 v[112:113], v[112:113], s[68:69], v[4:5]
    v_pk_fma_f32 v[114:115], v[114:115], s[68:69], v[4:5]
    v_pk_fma_f32 v[116:117], v[116:117], s[68:69], v[4:5]
    v_pk_fma_f32 v[118:119], v[118:119], s[68:69], v[4:5]
    v_pk_fma_f32 v[120:121], v[120:121], s[68:69], v[4:5]
    v_pk_fma_f32 v[122:123], v[122:123], s[68:69], v[4:5]
    v_pk_fma_f32 v[124:125], v[124:125], s[68:69], v[4:5]
    v_pk_fma_f32 v[126:127], v[126:127], s[68:69], v[4:5]
    v_pk_mul_f32 v[112:113], v[112:113], v[160:161]
    v_pk_mul_f32 v[114:115], v[114:115], v[162:163]
    v_pk_mul_f32 v[116:117], v[116:117], v[164:165]
    v_pk_mul_f32 v[118:119], v[118:119], v[166:167]
    v_pk_mul_f32 v[120:121], v[120:121], v[168:169]
    v_pk_mul_f32 v[122:123], v[122:123], v[170:171]
    v_pk_mul_f32 v[124:125], v[124:125], v[172:173]
    v_pk_mul_f32 v[126:127], v[126:127], v[174:175]
    v_exp_f32 v112, v112
    v_exp_f32 v114, v114
    v_exp_f32 v116, v116
    v_exp_f32 v118, v118
    v_exp_f32 v120, v120
    v_exp_f32 v122, v122
    v_exp_f32 v124, v124
    v_exp_f32 v126, v126
    v_exp_f32 v113, v113
    v_exp_f32 v115, v115
    v_exp_f32 v117, v117
    v_exp_f32 v119, v119
    v_exp_f32 v121, v121
    v_exp_f32 v123, v123
    v_exp_f32 v125, v125
    v_exp_f32 v127, v127
    v_pk_add_f32 v[112:113], v[112:113], v[20:21]
    v_pk_add_f32 v[114:115], v[114:115], v[20:21]
    v_pk_add_f32 v[116:117], v[116:117], v[20:21]
    v_pk_add_f32 v[118:119], v[118:119], v[20:21]
    v_pk_add_f32 v[120:121], v[120:121], v[20:21]
    v_pk_add_f32 v[122:123], v[122:123], v[20:21]
    v_pk_add_f32 v[124:125], v[124:125], v[20:21]
    v_pk_add_f32 v[126:127], v[126:127], v[20:21]
    v_rcp_f32 v112, v112
    v_rcp_f32 v114, v114
    v_rcp_f32 v116, v116
    v_rcp_f32 v118, v118
    v_rcp_f32 v120, v120
    v_rcp_f32 v122, v122
    v_rcp_f32 v124, v124
    v_rcp_f32 v126, v126
    v_rcp_f32 v113, v113
    v_rcp_f32 v115, v115
    v_rcp_f32 v117, v117
    v_rcp_f32 v119, v119
    v_rcp_f32 v121, v121
    v_rcp_f32 v123, v123
    v_rcp_f32 v125, v125
    v_rcp_f32 v127, v127
    v_pk_mul_f32 v[112:113], v[112:113], v[160:161]
    v_pk_mul_f32 v[114:115], v[114:115], v[162:163]
    v_pk_mul_f32 v[116:117], v[116:117], v[164:165]
    v_pk_mul_f32 v[118:119], v[118:119], v[166:167]
    v_pk_mul_f32 v[120:121], v[120:121], v[168:169]
    v_pk_mul_f32 v[122:123], v[122:123], v[170:171]
    v_pk_mul_f32 v[124:125], v[124:125], v[172:173]
    v_pk_mul_f32 v[126:127], v[126:127], v[174:175]
    v_cvt_pk_bf16_f32 v96, v112, v113
    v_cvt_pk_bf16_f32 v102, v124, v125
    v_cvt_pk_bf16_f32 v97, v114, v115
    v_cvt_pk_bf16_f32 v99, v118, v119
    v_cvt_pk_bf16_f32 v98, v116, v117
    v_cvt_pk_bf16_f32 v100, v120, v121
    v_cvt_pk_bf16_f32 v101, v122, v123
    v_cvt_pk_bf16_f32 v103, v126, v127
    global_store_dwordx4 v18, v[96:99], s[36:37] sc1
    global_store_dwordx4 v18, v[100:103], s[36:37] offset:1024 sc1
    s_nop 1
    v_add_u32 v18, 2048, v18
    ds_read_b128 v[32:35], v17 offset:512
    ds_read_b128 v[48:51], v17 offset:1280
    ds_read_b128 v[36:39], v17 offset:528
    ds_read_b128 v[52:55], v17 offset:1296
    ds_read_b128 v[40:43], v17 offset:576
    ds_read_b128 v[56:59], v17 offset:1344
    ds_read_b128 v[44:47], v17 offset:592
    ds_read_b128 v[60:63], v17 offset:1360
    s_waitcnt lgkmcnt(14)
    v_pk_fma_f32 v[112:113], v[64:65], v[2:3], v[80:81] op_sel:[0,1,0] op_sel_hi:[1,1,1] neg_lo:[0,1,0] neg_hi:[0,1,0]
    v_pk_fma_f32 v[114:115], v[66:67], v[2:3], v[82:83] op_sel:[0,1,0] op_sel_hi:[1,1,1] neg_lo:[0,1,0] neg_hi:[0,1,0]
    s_waitcnt lgkmcnt(12)
    v_pk_fma_f32 v[116:117], v[68:69], v[2:3], v[84:85] op_sel:[0,1,0] op_sel_hi:[1,1,1] neg_lo:[0,1,0] neg_hi:[0,1,0]
    v_pk_fma_f32 v[118:119], v[70:71], v[2:3], v[86:87] op_sel:[0,1,0] op_sel_hi:[1,1,1] neg_lo:[0,1,0] neg_hi:[0,1,0]
    s_waitcnt lgkmcnt(10)
    v_pk_fma_f32 v[120:121], v[72:73], v[2:3], v[88:89] op_sel:[0,1,0] op_sel_hi:[1,1,1] neg_lo:[0,1,0] neg_hi:[0,1,0]
    v_pk_fma_f32 v[122:123], v[74:75], v[2:3], v[90:91] op_sel:[0,1,0] op_sel_hi:[1,1,1] neg_lo:[0,1,0] neg_hi:[0,1,0]
    s_waitcnt lgkmcnt(8)
    v_pk_fma_f32 v[124:125], v[76:77], v[2:3], v[92:93] op_sel:[0,1,0] op_sel_hi:[1,1,1] neg_lo:[0,1,0] neg_hi:[0,1,0]
    v_pk_fma_f32 v[126:127], v[78:79], v[2:3], v[94:95] op_sel:[0,1,0] op_sel_hi:[1,1,1] neg_lo:[0,1,0] neg_hi:[0,1,0]
    v_pk_fma_f32 v[176:177], v[176:177], v[2:3], v[112:113] op_sel_hi:[1,0,1]
    v_pk_fma_f32 v[178:179], v[178:179], v[2:3], v[114:115] op_sel_hi:[1,0,1]
    v_pk_fma_f32 v[180:181], v[180:181], v[2:3], v[116:117] op_sel_hi:[1,0,1]
    v_pk_fma_f32 v[182:183], v[182:183], v[2:3], v[118:119] op_sel_hi:[1,0,1]
    v_pk_fma_f32 v[184:185], v[184:185], v[2:3], v[120:121] op_sel_hi:[1,0,1]
    v_pk_fma_f32 v[186:187], v[186:187], v[2:3], v[122:123] op_sel_hi:[1,0,1]
    v_pk_fma_f32 v[188:189], v[188:189], v[2:3], v[124:125] op_sel_hi:[1,0,1]
    v_pk_fma_f32 v[190:191], v[190:191], v[2:3], v[126:127] op_sel_hi:[1,0,1]
    v_pk_mul_f32 v[112:113], v[176:177], v[176:177]
    v_pk_mul_f32 v[114:115], v[178:179], v[178:179]
    v_pk_mul_f32 v[116:117], v[180:181], v[180:181]
    v_pk_mul_f32 v[118:119], v[182:183], v[182:183]
    v_pk_mul_f32 v[120:121], v[184:185], v[184:185]
    v_pk_mul_f32 v[122:123], v[186:187], v[186:187]
    v_pk_mul_f32 v[124:125], v[188:189], v[188:189]
    v_pk_mul_f32 v[126:127], v[190:191], v[190:191]
    v_pk_fma_f32 v[112:113], v[112:113], s[68:69], v[4:5]
    v_pk_fma_f32 v[114:115], v[114:115], s[68:69], v[4:5]
    v_pk_fma_f32 v[116:117], v[116:117], s[68:69], v[4:5]
    v_pk_fma_f32 v[118:119], v[118:119], s[68:69], v[4:5]
    v_pk_fma_f32 v[120:121], v[120:121], s[68:69], v[4:5]
    v_pk_fma_f32 v[122:123], v[122:123], s[68:69], v[4:5]
    v_pk_fma_f32 v[124:125], v[124:125], s[68:69], v[4:5]
    v_pk_fma_f32 v[126:127], v[126:127], s[68:69], v[4:5]
    v_pk_mul_f32 v[112:113], v[112:113], v[176:177]
    v_pk_mul_f32 v[114:115], v[114:115], v[178:179]
    v_pk_mul_f32 v[116:117], v[116:117], v[180:181]
    v_pk_mul_f32 v[118:119], v[118:119], v[182:183]
    v_pk_mul_f32 v[120:121], v[120:121], v[184:185]
    v_pk_mul_f32 v[122:123], v[122:123], v[186:187]
    v_pk_mul_f32 v[124:125], v[124:125], v[188:189]
    v_pk_mul_f32 v[126:127], v[126:127], v[190:191]
    v_exp_f32 v112, v112
    v_exp_f32 v114, v114
    v_exp_f32 v116, v116
    v_exp_f32 v118, v118
    v_exp_f32 v120, v120
    v_exp_f32 v122, v122
    v_exp_f32 v124, v124
    v_exp_f32 v126, v126
    v_exp_f32 v113, v113
    v_exp_f32 v115, v115
    v_exp_f32 v117, v117
    v_exp_f32 v119, v119
    v_exp_f32 v121, v121
    v_exp_f32 v123, v123
    v_exp_f32 v125, v125
    v_exp_f32 v127, v127
    v_pk_add_f32 v[112:113], v[112:113], v[20:21]
    v_pk_add_f32 v[114:115], v[114:115], v[20:21]
    v_pk_add_f32 v[116:117], v[116:117], v[20:21]
    v_pk_add_f32 v[118:119], v[118:119], v[20:21]
    v_pk_add_f32 v[120:121], v[120:121], v[20:21]
    v_pk_add_f32 v[122:123], v[122:123], v[20:21]
    v_pk_add_f32 v[124:125], v[124:125], v[20:21]
    v_pk_add_f32 v[126:127], v[126:127], v[20:21]
    v_rcp_f32 v112, v112
    v_rcp_f32 v114, v114
    v_rcp_f32 v116, v116
    v_rcp_f32 v118, v118
    v_rcp_f32 v120, v120
    v_rcp_f32 v122, v122
    v_rcp_f32 v124, v124
    v_rcp_f32 v126, v126
    v_rcp_f32 v113, v113
    v_rcp_f32 v115, v115
    v_rcp_f32 v117, v117
    v_rcp_f32 v119, v119
    v_rcp_f32 v121, v121
    v_rcp_f32 v123, v123
    v_rcp_f32 v125, v125
    v_rcp_f32 v127, v127
    v_pk_mul_f32 v[112:113], v[112:113], v[176:177]
    v_pk_mul_f32 v[114:115], v[114:115], v[178:179]
    v_pk_mul_f32 v[116:117], v[116:117], v[180:181]
    v_pk_mul_f32 v[118:119], v[118:119], v[182:183]
    v_pk_mul_f32 v[120:121], v[120:121], v[184:185]
    v_pk_mul_f32 v[122:123], v[122:123], v[186:187]
    v_pk_mul_f32 v[124:125], v[124:125], v[188:189]
    v_pk_mul_f32 v[126:127], v[126:127], v[190:191]
    v_cvt_pk_bf16_f32 v104, v112, v113
    v_cvt_pk_bf16_f32 v110, v124, v125
    v_cvt_pk_bf16_f32 v105, v114, v115
    v_cvt_pk_bf16_f32 v107, v118, v119
    v_cvt_pk_bf16_f32 v106, v116, v117
    v_cvt_pk_bf16_f32 v108, v120, v121
    v_cvt_pk_bf16_f32 v109, v122, v123
    v_cvt_pk_bf16_f32 v111, v126, v127
    global_store_dwordx4 v18, v[104:107], s[36:37] sc1
    global_store_dwordx4 v18, v[108:111], s[36:37] offset:1024 sc1
    s_nop 1
    v_add_u32 v18, 2048, v18
    ds_read_b128 v[64:67], v17 offset:640
    ds_read_b128 v[80:83], v17 offset:1408
    ds_read_b128 v[68:71], v17 offset:656
    ds_read_b128 v[84:87], v17 offset:1424
    ds_read_b128 v[72:75], v17 offset:704
    ds_read_b128 v[88:91], v17 offset:1472
    ds_read_b128 v[76:79], v17 offset:720
    ds_read_b128 v[92:95], v17 offset:1488
    s_waitcnt lgkmcnt(14)
    v_pk_fma_f32 v[112:113], v[32:33], v[2:3], v[48:49] op_sel:[0,1,0] op_sel_hi:[1,1,1] neg_lo:[0,1,0] neg_hi:[0,1,0]
    v_pk_fma_f32 v[114:115], v[34:35], v[2:3], v[50:51] op_sel:[0,1,0] op_sel_hi:[1,1,1] neg_lo:[0,1,0] neg_hi:[0,1,0]
    s_waitcnt lgkmcnt(12)
    v_pk_fma_f32 v[116:117], v[36:37], v[2:3], v[52:53] op_sel:[0,1,0] op_sel_hi:[1,1,1] neg_lo:[0,1,0] neg_hi:[0,1,0]
    v_pk_fma_f32 v[118:119], v[38:39], v[2:3], v[54:55] op_sel:[0,1,0] op_sel_hi:[1,1,1] neg_lo:[0,1,0] neg_hi:[0,1,0]
    s_waitcnt lgkmcnt(10)
    v_pk_fma_f32 v[120:121], v[40:41], v[2:3], v[56:57] op_sel:[0,1,0] op_sel_hi:[1,1,1] neg_lo:[0,1,0] neg_hi:[0,1,0]
    v_pk_fma_f32 v[122:123], v[42:43], v[2:3], v[58:59] op_sel:[0,1,0] op_sel_hi:[1,1,1] neg_lo:[0,1,0] neg_hi:[0,1,0]
    s_waitcnt lgkmcnt(8)
    v_pk_fma_f32 v[124:125], v[44:45], v[2:3], v[60:61] op_sel:[0,1,0] op_sel_hi:[1,1,1] neg_lo:[0,1,0] neg_hi:[0,1,0]
    v_pk_fma_f32 v[126:127], v[46:47], v[2:3], v[62:63] op_sel:[0,1,0] op_sel_hi:[1,1,1] neg_lo:[0,1,0] neg_hi:[0,1,0]
    v_pk_fma_f32 v[192:193], v[192:193], v[2:3], v[112:113] op_sel_hi:[1,0,1]
    v_pk_fma_f32 v[194:195], v[194:195], v[2:3], v[114:115] op_sel_hi:[1,0,1]
    v_pk_fma_f32 v[196:197], v[196:197], v[2:3], v[116:117] op_sel_hi:[1,0,1]
    v_pk_fma_f32 v[198:199], v[198:199], v[2:3], v[118:119] op_sel_hi:[1,0,1]
    v_pk_fma_f32 v[200:201], v[200:201], v[2:3], v[120:121] op_sel_hi:[1,0,1]
    v_pk_fma_f32 v[202:203], v[202:203], v[2:3], v[122:123] op_sel_hi:[1,0,1]
    v_pk_fma_f32 v[204:205], v[204:205], v[2:3], v[124:125] op_sel_hi:[1,0,1]
    v_pk_fma_f32 v[206:207], v[206:207], v[2:3], v[126:127] op_sel_hi:[1,0,1]
    v_pk_mul_f32 v[112:113], v[192:193], v[192:193]
    v_pk_mul_f32 v[114:115], v[194:195], v[194:195]
    v_pk_mul_f32 v[116:117], v[196:197], v[196:197]
    v_pk_mul_f32 v[118:119], v[198:199], v[198:199]
    v_pk_mul_f32 v[120:121], v[200:201], v[200:201]
    v_pk_mul_f32 v[122:123], v[202:203], v[202:203]
    v_pk_mul_f32 v[124:125], v[204:205], v[204:205]
    v_pk_mul_f32 v[126:127], v[206:207], v[206:207]
    v_pk_fma_f32 v[112:113], v[112:113], s[68:69], v[4:5]
    v_pk_fma_f32 v[114:115], v[114:115], s[68:69], v[4:5]
    v_pk_fma_f32 v[116:117], v[116:117], s[68:69], v[4:5]
    v_pk_fma_f32 v[118:119], v[118:119], s[68:69], v[4:5]
    v_pk_fma_f32 v[120:121], v[120:121], s[68:69], v[4:5]
    v_pk_fma_f32 v[122:123], v[122:123], s[68:69], v[4:5]
    v_pk_fma_f32 v[124:125], v[124:125], s[68:69], v[4:5]
    v_pk_fma_f32 v[126:127], v[126:127], s[68:69], v[4:5]
    v_pk_mul_f32 v[112:113], v[112:113], v[192:193]
    v_pk_mul_f32 v[114:115], v[114:115], v[194:195]
    v_pk_mul_f32 v[116:117], v[116:117], v[196:197]
    v_pk_mul_f32 v[118:119], v[118:119], v[198:199]
    v_pk_mul_f32 v[120:121], v[120:121], v[200:201]
    v_pk_mul_f32 v[122:123], v[122:123], v[202:203]
    v_pk_mul_f32 v[124:125], v[124:125], v[204:205]
    v_pk_mul_f32 v[126:127], v[126:127], v[206:207]
    v_exp_f32 v112, v112
    v_exp_f32 v114, v114
    v_exp_f32 v116, v116
    v_exp_f32 v118, v118
    v_exp_f32 v120, v120
    v_exp_f32 v122, v122
    v_exp_f32 v124, v124
    v_exp_f32 v126, v126
    v_exp_f32 v113, v113
    v_exp_f32 v115, v115
    v_exp_f32 v117, v117
    v_exp_f32 v119, v119
    v_exp_f32 v121, v121
    v_exp_f32 v123, v123
    v_exp_f32 v125, v125
    v_exp_f32 v127, v127
    v_pk_add_f32 v[112:113], v[112:113], v[20:21]
    v_pk_add_f32 v[114:115], v[114:115], v[20:21]
    v_pk_add_f32 v[116:117], v[116:117], v[20:21]
    v_pk_add_f32 v[118:119], v[118:119], v[20:21]
    v_pk_add_f32 v[120:121], v[120:121], v[20:21]
    v_pk_add_f32 v[122:123], v[122:123], v[20:21]
    v_pk_add_f32 v[124:125], v[124:125], v[20:21]
    v_pk_add_f32 v[126:127], v[126:127], v[20:21]
    v_rcp_f32 v112, v112
    v_rcp_f32 v114, v114
    v_rcp_f32 v116, v116
    v_rcp_f32 v118, v118
    v_rcp_f32 v120, v120
    v_rcp_f32 v122, v122
    v_rcp_f32 v124, v124
    v_rcp_f32 v126, v126
    v_rcp_f32 v113, v113
    v_rcp_f32 v115, v115
    v_rcp_f32 v117, v117
    v_rcp_f32 v119, v119
    v_rcp_f32 v121, v121
    v_rcp_f32 v123, v123
    v_rcp_f32 v125, v125
    v_rcp_f32 v127, v127
    v_pk_mul_f32 v[112:113], v[112:113], v[192:193]
    v_pk_mul_f32 v[114:115], v[114:115], v[194:195]
    v_pk_mul_f32 v[116:117], v[116:117], v[196:197]
    v_pk_mul_f32 v[118:119], v[118:119], v[198:199]
    v_pk_mul_f32 v[120:121], v[120:121], v[200:201]
    v_pk_mul_f32 v[122:123], v[122:123], v[202:203]
    v_pk_mul_f32 v[124:125], v[124:125], v[204:205]
    v_pk_mul_f32 v[126:127], v[126:127], v[206:207]
    v_cvt_pk_bf16_f32 v96, v112, v113
    v_cvt_pk_bf16_f32 v102, v124, v125
    v_cvt_pk_bf16_f32 v97, v114, v115
    v_cvt_pk_bf16_f32 v99, v118, v119
    v_cvt_pk_bf16_f32 v98, v116, v117
    v_cvt_pk_bf16_f32 v100, v120, v121
    v_cvt_pk_bf16_f32 v101, v122, v123
    v_cvt_pk_bf16_f32 v103, v126, v127
    global_store_dwordx4 v18, v[96:99], s[36:37] sc1
    global_store_dwordx4 v18, v[100:103], s[36:37] offset:1024 sc1
    s_nop 1
    v_add_u32 v18, 2048, v18
    s_waitcnt lgkmcnt(6)
    v_pk_fma_f32 v[112:113], v[64:65], v[2:3], v[80:81] op_sel:[0,1,0] op_sel_hi:[1,1,1] neg_lo:[0,1,0] neg_hi:[0,1,0]
    v_pk_fma_f32 v[114:115], v[66:67], v[2:3], v[82:83] op_sel:[0,1,0] op_sel_hi:[1,1,1] neg_lo:[0,1,0] neg_hi:[0,1,0]
    s_waitcnt lgkmcnt(4)
    v_pk_fma_f32 v[116:117], v[68:69], v[2:3], v[84:85] op_sel:[0,1,0] op_sel_hi:[1,1,1] neg_lo:[0,1,0] neg_hi:[0,1,0]
    v_pk_fma_f32 v[118:119], v[70:71], v[2:3], v[86:87] op_sel:[0,1,0] op_sel_hi:[1,1,1] neg_lo:[0,1,0] neg_hi:[0,1,0]
    s_waitcnt lgkmcnt(2)
    v_pk_fma_f32 v[120:121], v[72:73], v[2:3], v[88:89] op_sel:[0,1,0] op_sel_hi:[1,1,1] neg_lo:[0,1,0] neg_hi:[0,1,0]
    v_pk_fma_f32 v[122:123], v[74:75], v[2:3], v[90:91] op_sel:[0,1,0] op_sel_hi:[1,1,1] neg_lo:[0,1,0] neg_hi:[0,1,0]
    s_waitcnt lgkmcnt(0)
    v_pk_fma_f32 v[124:125], v[76:77], v[2:3], v[92:93] op_sel:[0,1,0] op_sel_hi:[1,1,1] neg_lo:[0,1,0] neg_hi:[0,1,0]
    v_pk_fma_f32 v[126:127], v[78:79], v[2:3], v[94:95] op_sel:[0,1,0] op_sel_hi:[1,1,1] neg_lo:[0,1,0] neg_hi:[0,1,0]
    v_pk_fma_f32 v[208:209], v[208:209], v[2:3], v[112:113] op_sel_hi:[1,0,1]
    v_pk_fma_f32 v[210:211], v[210:211], v[2:3], v[114:115] op_sel_hi:[1,0,1]
    v_pk_fma_f32 v[212:213], v[212:213], v[2:3], v[116:117] op_sel_hi:[1,0,1]
    v_pk_fma_f32 v[214:215], v[214:215], v[2:3], v[118:119] op_sel_hi:[1,0,1]
    v_pk_fma_f32 v[216:217], v[216:217], v[2:3], v[120:121] op_sel_hi:[1,0,1]
    v_pk_fma_f32 v[218:219], v[218:219], v[2:3], v[122:123] op_sel_hi:[1,0,1]
    v_pk_fma_f32 v[220:221], v[220:221], v[2:3], v[124:125] op_sel_hi:[1,0,1]
    v_pk_fma_f32 v[222:223], v[222:223], v[2:3], v[126:127] op_sel_hi:[1,0,1]
    v_pk_mul_f32 v[112:113], v[208:209], v[208:209]
    v_pk_mul_f32 v[114:115], v[210:211], v[210:211]
    v_pk_mul_f32 v[116:117], v[212:213], v[212:213]
    v_pk_mul_f32 v[118:119], v[214:215], v[214:215]
    v_pk_mul_f32 v[120:121], v[216:217], v[216:217]
    v_pk_mul_f32 v[122:123], v[218:219], v[218:219]
    v_pk_mul_f32 v[124:125], v[220:221], v[220:221]
    v_pk_mul_f32 v[126:127], v[222:223], v[222:223]
    v_pk_fma_f32 v[112:113], v[112:113], s[68:69], v[4:5]
    v_pk_fma_f32 v[114:115], v[114:115], s[68:69], v[4:5]
    v_pk_fma_f32 v[116:117], v[116:117], s[68:69], v[4:5]
    v_pk_fma_f32 v[118:119], v[118:119], s[68:69], v[4:5]
    v_pk_fma_f32 v[120:121], v[120:121], s[68:69], v[4:5]
    v_pk_fma_f32 v[122:123], v[122:123], s[68:69], v[4:5]
    v_pk_fma_f32 v[124:125], v[124:125], s[68:69], v[4:5]
    v_pk_fma_f32 v[126:127], v[126:127], s[68:69], v[4:5]
    v_pk_mul_f32 v[112:113], v[112:113], v[208:209]
    v_pk_mul_f32 v[114:115], v[114:115], v[210:211]
    v_pk_mul_f32 v[116:117], v[116:117], v[212:213]
    v_pk_mul_f32 v[118:119], v[118:119], v[214:215]
    v_pk_mul_f32 v[120:121], v[120:121], v[216:217]
    v_pk_mul_f32 v[122:123], v[122:123], v[218:219]
    v_pk_mul_f32 v[124:125], v[124:125], v[220:221]
    v_pk_mul_f32 v[126:127], v[126:127], v[222:223]
    v_exp_f32 v112, v112
    v_exp_f32 v114, v114
    v_exp_f32 v116, v116
    v_exp_f32 v118, v118
    v_exp_f32 v120, v120
    v_exp_f32 v122, v122
    v_exp_f32 v124, v124
    v_exp_f32 v126, v126
    v_exp_f32 v113, v113
    v_exp_f32 v115, v115
    v_exp_f32 v117, v117
    v_exp_f32 v119, v119
    v_exp_f32 v121, v121
    v_exp_f32 v123, v123
    v_exp_f32 v125, v125
    v_exp_f32 v127, v127
    v_pk_add_f32 v[112:113], v[112:113], v[20:21]
    v_pk_add_f32 v[114:115], v[114:115], v[20:21]
    v_pk_add_f32 v[116:117], v[116:117], v[20:21]
    v_pk_add_f32 v[118:119], v[118:119], v[20:21]
    v_pk_add_f32 v[120:121], v[120:121], v[20:21]
    v_pk_add_f32 v[122:123], v[122:123], v[20:21]
    v_pk_add_f32 v[124:125], v[124:125], v[20:21]
    v_pk_add_f32 v[126:127], v[126:127], v[20:21]
    v_rcp_f32 v112, v112
    v_rcp_f32 v114, v114
    v_rcp_f32 v116, v116
    v_rcp_f32 v118, v118
    v_rcp_f32 v120, v120
    v_rcp_f32 v122, v122
    v_rcp_f32 v124, v124
    v_rcp_f32 v126, v126
    v_rcp_f32 v113, v113
    v_rcp_f32 v115, v115
    v_rcp_f32 v117, v117
    v_rcp_f32 v119, v119
    v_rcp_f32 v121, v121
    v_rcp_f32 v123, v123
    v_rcp_f32 v125, v125
    v_rcp_f32 v127, v127
    v_pk_mul_f32 v[112:113], v[112:113], v[208:209]
    v_pk_mul_f32 v[114:115], v[114:115], v[210:211]
    v_pk_mul_f32 v[116:117], v[116:117], v[212:213]
    v_pk_mul_f32 v[118:119], v[118:119], v[214:215]
    v_pk_mul_f32 v[120:121], v[120:121], v[216:217]
    v_pk_mul_f32 v[122:123], v[122:123], v[218:219]
    v_pk_mul_f32 v[124:125], v[124:125], v[220:221]
    v_pk_mul_f32 v[126:127], v[126:127], v[222:223]
    v_cvt_pk_bf16_f32 v104, v112, v113
    v_cvt_pk_bf16_f32 v110, v124, v125
    v_cvt_pk_bf16_f32 v105, v114, v115
    v_cvt_pk_bf16_f32 v107, v118, v119
    v_cvt_pk_bf16_f32 v106, v116, v117
    v_cvt_pk_bf16_f32 v108, v120, v121
    v_cvt_pk_bf16_f32 v109, v122, v123
    v_cvt_pk_bf16_f32 v111, v126, v127
    global_store_dwordx4 v18, v[104:107], s[36:37] sc1
    global_store_dwordx4 v18, v[108:111], s[36:37] offset:1024 sc1
    s_branch L_cons_pub
L_cons_m5:
    s_mov_b32 s60, 0
    v_mov_b32 v21, 0x3f803f80
    v_and_b32 v17, 3, v0
    v_lshrrev_b32 v18, 2, v0
    v_and_b32 v18, 1, v18
    v_lshl_add_u32 v17, v18, 3, v17
    v_lshrrev_b32 v18, 3, v0
    v_and_b32 v18, 1, v18
    v_lshl_add_u32 v17, v18, 2, v17
    v_lshrrev_b32 v18, 4, v0
    v_and_b32 v18, 1, v18
    v_lshl_add_u32 v17, v18, 4, v17
    v_lshrrev_b32 v18, 5, v0
    s_lshl_b32 s13, s8, 1
    v_add_u32 v18, s13, v18
    v_mul_u32_u24 v18, 192, v18
    v_add_u32 v17, v17, v18
    v_lshlrev_b32 v20, 2, v17
    v_add_u32 v20, 132096, v20
    s_barrier
    v_add_u32 v1, s60, v8
    v_add_u32 v2, s60, v9
    v_add_u32 v3, s60, v10
    v_add_u32 v4, s60, v11
    v_add_u32 v5, s60, v12
    v_add_u32 v6, s60, v13
    ds_read_b128 v[32:35], v1
    ds_read_b64_tr_b16 v[36:37], v5 offset:0
    ds_read_b64_tr_b16 v[38:39], v5 offset:512
    ds_read_b64_tr_b16 v[40:41], v6 offset:0
    ds_read_b64_tr_b16 v[42:43], v6 offset:512
    ds_read_b64_tr_b16 v[44:45], v5 offset:8192
    ds_read_b64_tr_b16 v[46:47], v5 offset:8704
    ds_read_b64_tr_b16 v[48:49], v6 offset:8192
    ds_read_b64_tr_b16 v[50:51], v6 offset:8704
    ds_read_b64_tr_b16 v[52:53], v5 offset:16384
    ds_read_b64_tr_b16 v[54:55], v5 offset:16896
    s_waitcnt lgkmcnt(0)
    v_mfma_f32_32x32x16_bf16 v[128:143], v[36:39], v[32:35], v[128:143]
    ds_read_b128 v[64:67], v2
    ds_read_b64_tr_b16 v[68:69], v5 offset:2048
    ds_read_b64_tr_b16 v[70:71], v5 offset:2560
    v_mfma_f32_32x32x16_bf16 v[144:159], v[40:43], v[32:35], v[144:159]
    ds_read_b64_tr_b16 v[72:73], v6 offset:2048
    ds_read_b64_tr_b16 v[74:75], v6 offset:2560
    ds_read_b64_tr_b16 v[76:77], v5 offset:10240
    v_mfma_f32_32x32x16_bf16 v[160:175], v[44:47], v[32:35], v[160:175]
    ds_read_b64_tr_b16 v[78:79], v5 offset:10752
    ds_read_b64_tr_b16 v[80:81], v6 offset:10240
    ds_read_b64_tr_b16 v[82:83], v6 offset:10752
    v_mfma_f32_32x32x16_bf16 v[176:191], v[48:51], v[32:35], v[176:191]
    ds_read_b64_tr_b16 v[84:85], v5 offset:18432
    ds_read_b64_tr_b16 v[86:87], v5 offset:18944
    v_mfma_f32_32x32x16_bf16 v[192:207], v[52:55], v[32:35], v[192:207]
    s_and_b32 s13, s78, 1
    s_cbranch_scc0 Lmcs_55
    s_cmp_eq_u32 s8, 0
    s_cbranch_scc0 Lmcs_55
    v_dot2_f32_bf16 v24, v36, v21, 0
    v_dot2_f32_bf16 v24, v37, v21, v24
    v_dot2_f32_bf16 v24, v38, v21, v24
    v_dot2_f32_bf16 v24, v39, v21, v24
    v_dot2_f32_bf16 v25, v40, v21, 0
    v_dot2_f32_bf16 v25, v41, v21, v25
    v_dot2_f32_bf16 v25, v42, v21, v25
    v_dot2_f32_bf16 v25, v43, v21, v25
    v_dot2_f32_bf16 v26, v44, v21, 0
    v_dot2_f32_bf16 v26, v45, v21, v26
    v_dot2_f32_bf16 v26, v46, v21, v26
    v_dot2_f32_bf16 v26, v47, v21, v26
    v_dot2_f32_bf16 v27, v48, v21, 0
    v_dot2_f32_bf16 v27, v49, v21, v27
    v_dot2_f32_bf16 v27, v50, v21, v27
    v_dot2_f32_bf16 v27, v51, v21, v27
    v_dot2_f32_bf16 v28, v52, v21, 0
    v_dot2_f32_bf16 v28, v53, v21, v28
    v_dot2_f32_bf16 v28, v54, v21, v28
    v_dot2_f32_bf16 v28, v55, v21, v28
Lmcs_55:
    s_and_b32 s13, s78, 2
    s_cbranch_scc0 Lmst_56
    v_dot2_f32_bf16 v208, v32, v21, 0
    v_dot2_f32_bf16 v210, v32, v32, 0
    v_dot2_f32_bf16 v209, v33, v21, 0
    v_dot2_f32_bf16 v211, v33, v33, 0
    v_dot2_f32_bf16 v208, v34, v21, v208
    v_dot2_f32_bf16 v210, v34, v34, v210
    v_dot2_f32_bf16 v209, v35, v21, v209
    v_dot2_f32_bf16 v211, v35, v35, v211
Lmst_56:
    s_waitcnt lgkmcnt(0)
    v_mfma_f32_32x32x16_bf16 v[128:143], v[68:71], v[64:67], v[128:143]
    ds_read_b128 v[32:35], v3
    ds_read_b64_tr_b16 v[36:37], v5 offset:4096
    ds_read_b64_tr_b16 v[38:39], v5 offset:4608
    v_mfma_f32_32x32x16_bf16 v[144:159], v[72:75], v[64:67], v[144:159]
    ds_read_b64_tr_b16 v[40:41], v6 offset:4096
    ds_read_b64_tr_b16 v[42:43], v6 offset:4608
    ds_read_b64_tr_b16 v[44:45], v5 offset:12288
    v_mfma_f32_32x32x16_bf16 v[160:175], v[76:79], v[64:67], v[160:175]
    ds_read_b64_tr_b16 v[46:47], v5 offset:12800
    ds_read_b64_tr_b16 v[48:49], v6 offset:12288
    ds_read_b64_tr_b16 v[50:51], v6 offset:12800
    v_mfma_f32_32x32x16_bf16 v[176:191], v[80:83], v[64:67], v[176:191]
    ds_read_b64_tr_b16 v[52:53], v5 offset:20480
    ds_read_b64_tr_b16 v[54:55], v5 offset:20992
    v_mfma_f32_32x32x16_bf16 v[192:207], v[84:87], v[64:67], v[192:207]
    s_and_b32 s13, s78, 1
    s_cbranch_scc0 Lmcs_57
    s_cmp_eq_u32 s8, 1
    s_cbranch_scc0 Lmcs_57
    v_dot2_f32_bf16 v24, v68, v21, 0
    v_dot2_f32_bf16 v24, v69, v21, v24
    v_dot2_f32_bf16 v24, v70, v21, v24
    v_dot2_f32_bf16 v24, v71, v21, v24
    v_dot2_f32_bf16 v25, v72, v21, 0
    v_dot2_f32_bf16 v25, v73, v21, v25
    v_dot2_f32_bf16 v25, v74, v21, v25
    v_dot2_f32_bf16 v25, v75, v21, v25
    v_dot2_f32_bf16 v26, v76, v21, 0
    v_dot2_f32_bf16 v26, v77, v21, v26
    v_dot2_f32_bf16 v26, v78, v21, v26
    v_dot2_f32_bf16 v26, v79, v21, v26
    v_dot2_f32_bf16 v27, v80, v21, 0
    v_dot2_f32_bf16 v27, v81, v21, v27
    v_dot2_f32_bf16 v27, v82, v21, v27
    v_dot2_f32_bf16 v27, v83, v21, v27
    v_dot2_f32_bf16 v28, v84, v21, 0
    v_dot2_f32_bf16 v28, v85, v21, v28
    v_dot2_f32_bf16 v28, v86, v21, v28
    v_dot2_f32_bf16 v28, v87, v21, v28
Lmcs_57:
    s_and_b32 s13, s78, 2
    s_cbranch_scc0 Lmst_58
    v_dot2_f32_bf16 v208, v64, v21, v208
    v_dot2_f32_bf16 v210, v64, v64, v210
    v_dot2_f32_bf16 v209, v65, v21, v209
    v_dot2_f32_bf16 v211, v65, v65, v211
    v_dot2_f32_bf16 v208, v66, v21, v208
    v_dot2_f32_bf16 v210, v66, v66, v210
    v_dot2_f32_bf16 v209, v67, v21, v209
    v_dot2_f32_bf16 v211, v67, v67, v211
Lmst_58:
    s_waitcnt lgkmcnt(0)
    v_mfma_f32_32x32x16_bf16 v[128:143], v[36:39], v[32:35], v[128:143]
    ds_read_b128 v[64:67], v4
    ds_read_b64_tr_b16 v[68:69], v5 offset:6144
    ds_read_b64_tr_b16 v[70:71], v5 offset:6656
    v_mfma_f32_32x32x16_bf16 v[144:159], v[40:43], v[32:35], v[144:159]
    ds_read_b64_tr_b16 v[72:73], v6 offset:6144
    ds_read_b64_tr_b16 v[74:75], v6 offset:6656
    ds_read_b64_tr_b16 v[76:77], v5 offset:14336
    v_mfma_f32_32x32x16_bf16 v[160:175], v[44:47], v[32:35], v[160:175]
    ds_read_b64_tr_b16 v[78:79], v5 offset:14848
    ds_read_b64_tr_b16 v[80:81], v6 offset:14336
    ds_read_b64_tr_b16 v[82:83], v6 offset:14848
    v_mfma_f32_32x32x16_bf16 v[176:191], v[48:51], v[32:35], v[176:191]
    ds_read_b64_tr_b16 v[84:85], v5 offset:22528
    ds_read_b64_tr_b16 v[86:87], v5 offset:23040
    v_mfma_f32_32x32x16_bf16 v[192:207], v[52:55], v[32:35], v[192:207]
    s_and_b32 s13, s78, 1
    s_cbranch_scc0 Lmcs_59
    s_cmp_eq_u32 s8, 2
    s_cbranch_scc0 Lmcs_59
    v_dot2_f32_bf16 v24, v36, v21, 0
    v_dot2_f32_bf16 v24, v37, v21, v24
    v_dot2_f32_bf16 v24, v38, v21, v24
    v_dot2_f32_bf16 v24, v39, v21, v24
    v_dot2_f32_bf16 v25, v40, v21, 0
    v_dot2_f32_bf16 v25, v41, v21, v25
    v_dot2_f32_bf16 v25, v42, v21, v25
    v_dot2_f32_bf16 v25, v43, v21, v25
    v_dot2_f32_bf16 v26, v44, v21, 0
    v_dot2_f32_bf16 v26, v45, v21, v26
    v_dot2_f32_bf16 v26, v46, v21, v26
    v_dot2_f32_bf16 v26, v47, v21, v26
    v_dot2_f32_bf16 v27, v48, v21, 0
    v_dot2_f32_bf16 v27, v49, v21, v27
    v_dot2_f32_bf16 v27, v50, v21, v27
    v_dot2_f32_bf16 v27, v51, v21, v27
    v_dot2_f32_bf16 v28, v52, v21, 0
    v_dot2_f32_bf16 v28, v53, v21, v28
    v_dot2_f32_bf16 v28, v54, v21, v28
    v_dot2_f32_bf16 v28, v55, v21, v28
Lmcs_59:
    s_and_b32 s13, s78, 2
    s_cbranch_scc0 Lmst_60
    v_dot2_f32_bf16 v208, v32, v21, v208
    v_dot2_f32_bf16 v210, v32, v32, v210
    v_dot2_f32_bf16 v209, v33, v21, v209
    v_dot2_f32_bf16 v211, v33, v33, v211
    v_dot2_f32_bf16 v208, v34, v21, v208
    v_dot2_f32_bf16 v210, v34, v34, v210
    v_dot2_f32_bf16 v209, v35, v21, v209
    v_dot2_f32_bf16 v211, v35, v35, v211
Lmst_60:
    s_waitcnt lgkmcnt(0)
    v_mfma_f32_32x32x16_bf16 v[128:143], v[68:71], v[64:67], v[128:143]
    s_barrier
    s_add_u32 s60, s60, 43008
    s_cmp_eq_u32 s60, 129024
    s_cselect_b32 s60, 0, s60
    v_mfma_f32_32x32x16_bf16 v[144:159], v[72:75], v[64:67], v[144:159]
    v_add_u32 v1, s60, v8
    v_add_u32 v2, s60, v9
    v_add_u32 v3, s60, v10
    v_add_u32 v4, s60, v11
    v_add_u32 v5, s60, v12
    v_add_u32 v6, s60, v13
    v_mfma_f32_32x32x16_bf16 v[160:175], v[76:79], v[64:67], v[160:175]
    ds_read_b128 v[32:35], v1
    ds_read_b64_tr_b16 v[36:37], v5 offset:0
    ds_read_b64_tr_b16 v[38:39], v5 offset:512
    ds_read_b64_tr_b16 v[40:41], v6 offset:0
    v_mfma_f32_32x32x16_bf16 v[176:191], v[80:83], v[64:67], v[176:191]
    ds_read_b64_tr_b16 v[42:43], v6 offset:512
    ds_read_b64_tr_b16 v[44:45], v5 offset:8192
    ds_read_b64_tr_b16 v[46:47], v5 offset:8704
    ds_read_b64_tr_b16 v[48:49], v6 offset:8192
    v_mfma_f32_32x32x16_bf16 v[192:207], v[84:87], v[64:67], v[192:207]
    ds_read_b64_tr_b16 v[50:51], v6 offset:8704
    ds_read_b64_tr_b16 v[52:53], v5 offset:16384
    ds_read_b64_tr_b16 v[54:55], v5 offset:16896
    s_and_b32 s13, s78, 1
    s_cbranch_scc0 Lmcs_61
    s_cmp_eq_u32 s8, 3
    s_cbranch_scc0 Lmcs_61
    v_dot2_f32_bf16 v24, v68, v21, 0
    v_dot2_f32_bf16 v24, v69, v21, v24
    v_dot2_f32_bf16 v24, v70, v21, v24
    v_dot2_f32_bf16 v24, v71, v21, v24
    v_dot2_f32_bf16 v25, v72, v21, 0
    v_dot2_f32_bf16 v25, v73, v21, v25
    v_dot2_f32_bf16 v25, v74, v21, v25
    v_dot2_f32_bf16 v25, v75, v21, v25
    v_dot2_f32_bf16 v26, v76, v21, 0
    v_dot2_f32_bf16 v26, v77, v21, v26
    v_dot2_f32_bf16 v26, v78, v21, v26
    v_dot2_f32_bf16 v26, v79, v21, v26
    v_dot2_f32_bf16 v27, v80, v21, 0
    v_dot2_f32_bf16 v27, v81, v21, v27
    v_dot2_f32_bf16 v27, v82, v21, v27
    v_dot2_f32_bf16 v27, v83, v21, v27
    v_dot2_f32_bf16 v28, v84, v21, 0
    v_dot2_f32_bf16 v28, v85, v21, v28
    v_dot2_f32_bf16 v28, v86, v21, v28
    v_dot2_f32_bf16 v28, v87, v21, v28
Lmcs_61:
    s_and_b32 s13, s78, 2
    s_cbranch_scc0 Lmst_62
    v_dot2_f32_bf16 v208, v64, v21, v208
    v_dot2_f32_bf16 v210, v64, v64, v210
    v_dot2_f32_bf16 v209, v65, v21, v209
    v_dot2_f32_bf16 v211, v65, v65, v211
    v_dot2_f32_bf16 v208, v66, v21, v208
    v_dot2_f32_bf16 v210, v66, v66, v210
    v_dot2_f32_bf16 v209, v67, v21, v209
    v_dot2_f32_bf16 v211, v67, v67, v211
Lmst_62:
    s_waitcnt lgkmcnt(0)
    v_mfma_f32_32x32x16_bf16 v[128:143], v[36:39], v[32:35], v[128:143]
    ds_read_b128 v[64:67], v2
    ds_read_b64_tr_b16 v[68:69], v5 offset:2048
    ds_read_b64_tr_b16 v[70:71], v5 offset:2560
    v_mfma_f32_32x32x16_bf16 v[144:159], v[40:43], v[32:35], v[144:159]
    ds_read_b64_tr_b16 v[72:73], v6 offset:2048
    ds_read_b64_tr_b16 v[74:75], v6 offset:2560
    ds_read_b64_tr_b16 v[76:77], v5 offset:10240
    v_mfma_f32_32x32x16_bf16 v[160:175], v[44:47], v[32:35], v[160:175]
    ds_read_b64_tr_b16 v[78:79], v5 offset:10752
    ds_read_b64_tr_b16 v[80:81], v6 offset:10240
    ds_read_b64_tr_b16 v[82:83], v6 offset:10752
    v_mfma_f32_32x32x16_bf16 v[176:191], v[48:51], v[32:35], v[176:191]
    ds_read_b64_tr_b16 v[84:85], v5 offset:18432
    ds_read_b64_tr_b16 v[86:87], v5 offset:18944
    v_mfma_f32_32x32x16_bf16 v[192:207], v[52:55], v[32:35], v[192:207]
    s_and_b32 s13, s78, 1
    s_cbranch_scc0 Lmcs_63
    s_cmp_eq_u32 s8, 0
    s_cbranch_scc0 Lmcs_63
    v_dot2_f32_bf16 v24, v36, v21, v24
    v_dot2_f32_bf16 v24, v37, v21, v24
    v_dot2_f32_bf16 v24, v38, v21, v24
    v_dot2_f32_bf16 v24, v39, v21, v24
    v_dot2_f32_bf16 v25, v40, v21, v25
    v_dot2_f32_bf16 v25, v41, v21, v25
    v_dot2_f32_bf16 v25, v42, v21, v25
    v_dot2_f32_bf16 v25, v43, v21, v25
    v_dot2_f32_bf16 v26, v44, v21, v26
    v_dot2_f32_bf16 v26, v45, v21, v26
    v_dot2_f32_bf16 v26, v46, v21, v26
    v_dot2_f32_bf16 v26, v47, v21, v26
    v_dot2_f32_bf16 v27, v48, v21, v27
    v_dot2_f32_bf16 v27, v49, v21, v27
    v_dot2_f32_bf16 v27, v50, v21, v27
    v_dot2_f32_bf16 v27, v51, v21, v27
    v_dot2_f32_bf16 v28, v52, v21, v28
    v_dot2_f32_bf16 v28, v53, v21, v28
    v_dot2_f32_bf16 v28, v54, v21, v28
    v_dot2_f32_bf16 v28, v55, v21, v28
    s_nop 2
    ds_write_b32 v20, v24 offset:0
    ds_write_b32 v20, v25 offset:128
    ds_write_b32 v20, v26 offset:256
    ds_write_b32 v20, v27 offset:384
    ds_write_b32 v20, v28 offset:512
    s_lshl_b32 s13, s8, 2
    s_add_u32 s13, s13, 163680
    v_mov_b32 v14, s13
    v_mov_b32 v15, 1
    ds_write_b32 v14, v15
Lmcs_63:
    s_and_b32 s13, s78, 2
    s_cbranch_scc0 Lmst_64
    v_dot2_f32_bf16 v208, v32, v21, v208
    v_dot2_f32_bf16 v210, v32, v32, v210
    v_dot2_f32_bf16 v209, v33, v21, v209
    v_dot2_f32_bf16 v211, v33, v33, v211
    v_dot2_f32_bf16 v208, v34, v21, v208
    v_dot2_f32_bf16 v210, v34, v34, v210
    v_dot2_f32_bf16 v209, v35, v21, v209
    v_dot2_f32_bf16 v211, v35, v35, v211
Lmst_64:
    s_waitcnt lgkmcnt(0)
    v_mfma_f32_32x32x16_bf16 v[128:143], v[68:71], v[64:67], v[128:143]
    ds_read_b128 v[32:35], v3
    ds_read_b64_tr_b16 v[36:37], v5 offset:4096
    ds_read_b64_tr_b16 v[38:39], v5 offset:4608
    v_mfma_f32_32x32x16_bf16 v[144:159], v[72:75], v[64:67], v[144:159]
    ds_read_b64_tr_b16 v[40:41], v6 offset:4096
    ds_read_b64_tr_b16 v[42:43], v6 offset:4608
    ds_read_b64_tr_b16 v[44:45], v5 offset:12288
    v_mfma_f32_32x32x16_bf16 v[160:175], v[76:79], v[64:67], v[160:175]
    ds_read_b64_tr_b16 v[46:47], v5 offset:12800
    ds_read_b64_tr_b16 v[48:49], v6 offset:12288
    ds_read_b64_tr_b16 v[50:51], v6 offset:12800
    v_mfma_f32_32x32x16_bf16 v[176:191], v[80:83], v[64:67], v[176:191]
    ds_read_b64_tr_b16 v[52:53], v5 offset:20480
    ds_read_b64_tr_b16 v[54:55], v5 offset:20992
    v_mfma_f32_32x32x16_bf16 v[192:207], v[84:87], v[64:67], v[192:207]
    s_and_b32 s13, s78, 1
    s_cbranch_scc0 Lmcs_65
    s_cmp_eq_u32 s8, 1
    s_cbranch_scc0 Lmcs_65
    v_dot2_f32_bf16 v24, v68, v21, v24
    v_dot2_f32_bf16 v24, v69, v21, v24
    v_dot2_f32_bf16 v24, v70, v21, v24
    v_dot2_f32_bf16 v24, v71, v21, v24
    v_dot2_f32_bf16 v25, v72, v21, v25
    v_dot2_f32_bf16 v25, v73, v21, v25
    v_dot2_f32_bf16 v25, v74, v21, v25
    v_dot2_f32_bf16 v25, v75, v21, v25
    v_dot2_f32_bf16 v26, v76, v21, v26
    v_dot2_f32_bf16 v26, v77, v21, v26
    v_dot2_f32_bf16 v26, v78, v21, v26
    v_dot2_f32_bf16 v26, v79, v21, v26
    v_dot2_f32_bf16 v27, v80, v21, v27
    v_dot2_f32_bf16 v27, v81, v21, v27
    v_dot2_f32_bf16 v27, v82, v21, v27
    v_dot2_f32_bf16 v27, v83, v21, v27
    v_dot2_f32_bf16 v28, v84, v21, v28
    v_dot2_f32_bf16 v28, v85, v21, v28
    v_dot2_f32_bf16 v28, v86, v21, v28
    v_dot2_f32_bf16 v28, v87, v21, v28
    s_nop 2
    ds_write_b32 v20, v24 offset:0
    ds_write_b32 v20, v25 offset:128
    ds_write_b32 v20, v26 offset:256
    ds_write_b32 v20, v27 offset:384
    ds_write_b32 v20, v28 offset:512
    s_lshl_b32 s13, s8, 2
    s_add_u32 s13, s13, 163680
    v_mov_b32 v14, s13
    v_mov_b32 v15, 1
    ds_write_b32 v14, v15
Lmcs_65:
    s_and_b32 s13, s78, 2
    s_cbranch_scc0 Lmst_66
    v_dot2_f32_bf16 v208, v64, v21, v208
    v_dot2_f32_bf16 v210, v64, v64, v210
    v_dot2_f32_bf16 v209, v65, v21, v209
    v_dot2_f32_bf16 v211, v65, v65, v211
    v_dot2_f32_bf16 v208, v66, v21, v208
    v_dot2_f32_bf16 v210, v66, v66, v210
    v_dot2_f32_bf16 v209, v67, v21, v209
    v_dot2_f32_bf16 v211, v67, v67, v211
Lmst_66:
    s_waitcnt lgkmcnt(0)
    v_mfma_f32_32x32x16_bf16 v[128:143], v[36:39], v[32:35], v[128:143]
    ds_read_b128 v[64:67], v4
    ds_read_b64_tr_b16 v[68:69], v5 offset:6144
    ds_read_b64_tr_b16 v[70:71], v5 offset:6656
    v_mfma_f32_32x32x16_bf16 v[144:159], v[40:43], v[32:35], v[144:159]
    ds_read_b64_tr_b16 v[72:73], v6 offset:6144
    ds_read_b64_tr_b16 v[74:75], v6 offset:6656
    ds_read_b64_tr_b16 v[76:77], v5 offset:14336
    v_mfma_f32_32x32x16_bf16 v[160:175], v[44:47], v[32:35], v[160:175]
    ds_read_b64_tr_b16 v[78:79], v5 offset:14848
    ds_read_b64_tr_b16 v[80:81], v6 offset:14336
    ds_read_b64_tr_b16 v[82:83], v6 offset:14848
    v_mfma_f32_32x32x16_bf16 v[176:191], v[48:51], v[32:35], v[176:191]
    ds_read_b64_tr_b16 v[84:85], v5 offset:22528
    ds_read_b64_tr_b16 v[86:87], v5 offset:23040
    v_mfma_f32_32x32x16_bf16 v[192:207], v[52:55], v[32:35], v[192:207]
    s_and_b32 s13, s78, 1
    s_cbranch_scc0 Lmcs_67
    s_cmp_eq_u32 s8, 2
    s_cbranch_scc0 Lmcs_67
    v_dot2_f32_bf16 v24, v36, v21, v24
    v_dot2_f32_bf16 v24, v37, v21, v24
    v_dot2_f32_bf16 v24, v38, v21, v24
    v_dot2_f32_bf16 v24, v39, v21, v24
    v_dot2_f32_bf16 v25, v40, v21, v25
    v_dot2_f32_bf16 v25, v41, v21, v25
    v_dot2_f32_bf16 v25, v42, v21, v25
    v_dot2_f32_bf16 v25, v43, v21, v25
    v_dot2_f32_bf16 v26, v44, v21, v26
    v_dot2_f32_bf16 v26, v45, v21, v26
    v_dot2_f32_bf16 v26, v46, v21, v26
    v_dot2_f32_bf16 v26, v47, v21, v26
    v_dot2_f32_bf16 v27, v48, v21, v27
    v_dot2_f32_bf16 v27, v49, v21, v27
    v_dot2_f32_bf16 v27, v50, v21, v27
    v_dot2_f32_bf16 v27, v51, v21, v27
    v_dot2_f32_bf16 v28, v52, v21, v28
    v_dot2_f32_bf16 v28, v53, v21, v28
    v_dot2_f32_bf16 v28, v54, v21, v28
    v_dot2_f32_bf16 v28, v55, v21, v28
    s_nop 2
    ds_write_b32 v20, v24 offset:0
    ds_write_b32 v20, v25 offset:128
    ds_write_b32 v20, v26 offset:256
    ds_write_b32 v20, v27 offset:384
    ds_write_b32 v20, v28 offset:512
    s_lshl_b32 s13, s8, 2
    s_add_u32 s13, s13, 163680
    v_mov_b32 v14, s13
    v_mov_b32 v15, 1
    ds_write_b32 v14, v15
Lmcs_67:
    s_and_b32 s13, s78, 2
    s_cbranch_scc0 Lmst_68
    v_dot2_f32_bf16 v208, v32, v21, v208
    v_dot2_f32_bf16 v210, v32, v32, v210
    v_dot2_f32_bf16 v209, v33, v21, v209
    v_dot2_f32_bf16 v211, v33, v33, v211
    v_dot2_f32_bf16 v208, v34, v21, v208
    v_dot2_f32_bf16 v210, v34, v34, v210
    v_dot2_f32_bf16 v209, v35, v21, v209
    v_dot2_f32_bf16 v211, v35, v35, v211
Lmst_68:
    s_waitcnt lgkmcnt(0)
    v_mfma_f32_32x32x16_bf16 v[128:143], v[68:71], v[64:67], v[128:143]
    s_barrier
    s_add_u32 s60, s60, 43008
    s_cmp_eq_u32 s60, 129024
    s_cselect_b32 s60, 0, s60
    v_mfma_f32_32x32x16_bf16 v[144:159], v[72:75], v[64:67], v[144:159]
    v_add_u32 v1, s60, v8
    v_add_u32 v2, s60, v9
    v_add_u32 v3, s60, v10
    v_add_u32 v4, s60, v11
    v_add_u32 v5, s60, v12
    v_add_u32 v6, s60, v13
    v_mfma_f32_32x32x16_bf16 v[160:175], v[76:79], v[64:67], v[160:175]
    ds_read_b128 v[32:35], v1
    ds_read_b64_tr_b16 v[36:37], v5 offset:0
    ds_read_b64_tr_b16 v[38:39], v5 offset:512
    ds_read_b64_tr_b16 v[40:41], v6 offset:0
    v_mfma_f32_32x32x16_bf16 v[176:191], v[80:83], v[64:67], v[176:191]
    ds_read_b64_tr_b16 v[42:43], v6 offset:512
    ds_read_b64_tr_b16 v[44:45], v5 offset:8192
    ds_read_b64_tr_b16 v[46:47], v5 offset:8704
    ds_read_b64_tr_b16 v[48:49], v6 offset:8192
    v_mfma_f32_32x32x16_bf16 v[192:207], v[84:87], v[64:67], v[192:207]
    ds_read_b64_tr_b16 v[50:51], v6 offset:8704
    ds_read_b64_tr_b16 v[52:53], v5 offset:16384
    ds_read_b64_tr_b16 v[54:55], v5 offset:16896
    s_and_b32 s13, s78, 1
    s_cbranch_scc0 Lmcs_69
    s_cmp_eq_u32 s8, 3
    s_cbranch_scc0 Lmcs_69
    v_dot2_f32_bf16 v24, v68, v21, v24
    v_dot2_f32_bf16 v24, v69, v21, v24
    v_dot2_f32_bf16 v24, v70, v21, v24
    v_dot2_f32_bf16 v24, v71, v21, v24
    v_dot2_f32_bf16 v25, v72, v21, v25
    v_dot2_f32_bf16 v25, v73, v21, v25
    v_dot2_f32_bf16 v25, v74, v21, v25
    v_dot2_f32_bf16 v25, v75, v21, v25
    v_dot2_f32_bf16 v26, v76, v21, v26
    v_dot2_f32_bf16 v26, v77, v21, v26
    v_dot2_f32_bf16 v26, v78, v21, v26
    v_dot2_f32_bf16 v26, v79, v21, v26
    v_dot2_f32_bf16 v27, v80, v21, v27
    v_dot2_f32_bf16 v27, v81, v21, v27
    v_dot2_f32_bf16 v27, v82, v21, v27
    v_dot2_f32_bf16 v27, v83, v21, v27
    v_dot2_f32_bf16 v28, v84, v21, v28
    v_dot2_f32_bf16 v28, v85, v21, v28
    v_dot2_f32_bf16 v28, v86, v21, v28
    v_dot2_f32_bf16 v28, v87, v21, v28
    s_nop 2
    ds_write_b32 v20, v24 offset:0
    ds_write_b32 v20, v25 offset:128
    ds_write_b32 v20, v26 offset:256
    ds_write_b32 v20, v27 offset:384
    ds_write_b32 v20, v28 offset:512
    s_lshl_b32 s13, s8, 2
    s_add_u32 s13, s13, 163680
    v_mov_b32 v14, s13
    v_mov_b32 v15, 1
    ds_write_b32 v14, v15
Lmcs_69:
    s_and_b32 s13, s78, 2
    s_cbranch_scc0 Lmst_70
    v_dot2_f32_bf16 v208, v64, v21, v208
    v_dot2_f32_bf16 v210, v64, v64, v210
    v_dot2_f32_bf16 v209, v65, v21, v209
    v_dot2_f32_bf16 v211, v65, v65, v211
    v_dot2_f32_bf16 v208, v66, v21, v208
    v_dot2_f32_bf16 v210, v66, v66, v210
    v_dot2_f32_bf16 v209, v67, v21, v209
    v_dot2_f32_bf16 v211, v67, v67, v211
Lmst_70:
    s_and_b32 s13, s78, 2
    s_cbranch_scc0 Lmsp_71
    s_nop 2
    v_mov_b32 v214, 163660
    ds_read_b32 v214, v214
    s_waitcnt lgkmcnt(0)
    v_readfirstlane_b32 s13, v214
    s_nop 0
    s_cmp_eq_u32 s13, 0
    s_cbranch_scc1 Lmsp_71
    s_andn2_b32 s78, s78, 2
    v_add_f32 v208, v208, v209
    v_add_f32 v209, v210, v211
    v_mov_b32 v210, v208
    v_mov_b32 v211, v209
    s_nop 0
    v_permlane32_swap_b32 v208, v210
    v_permlane32_swap_b32 v209, v211
    v_add_f32 v208, v208, v210
    v_add_f32 v209, v209, v211
    v_and_b32 v212, 31, v0
    s_lshl_b32 s13, s9, 7
    s_lshl_b32 s14, s8, 5
    s_add_u32 s13, s13, s14
    v_add_u32 v212, s13, v212
    v_lshlrev_b32 v212, 4, v212
    s_sub_u32 s13, s76, 3
    s_lshl_b32 s13, s13, 15
    s_add_u32 s13, s13, 7864320
    v_add_u32 v212, s13, v212
    v_mov_b32 v210, v209
    v_mov_b32 v209, v214
    v_mov_b32 v211, v214
    s_mov_b64 s[90:91], exec
    s_mov_b32 exec_hi, 0
    global_store_dwordx4 v212, v[208:211], s[36:37] sc1
    s_mov_b64 exec, s[90:91]
Lmsp_71:
    s_mov_b32 s63, 6
.p2align 6
Lmloop_72:
    s_waitcnt lgkmcnt(0)
    v_mfma_f32_32x32x16_bf16 v[128:143], v[36:39], v[32:35], v[128:143]
    ds_read_b128 v[64:67], v2
    ds_read_b64_tr_b16 v[68:69], v5 offset:2048
    ds_read_b64_tr_b16 v[70:71], v5 offset:2560
    v_mfma_f32_32x32x16_bf16 v[144:159], v[40:43], v[32:35], v[144:159]
    ds_read_b64_tr_b16 v[72:73], v6 offset:2048
    ds_read_b64_tr_b16 v[74:75], v6 offset:2560
    ds_read_b64_tr_b16 v[76:77], v5 offset:10240
    v_mfma_f32_32x32x16_bf16 v[160:175], v[44:47], v[32:35], v[160:175]
    ds_read_b64_tr_b16 v[78:79], v5 offset:10752
    ds_read_b64_tr_b16 v[80:81], v6 offset:10240
    ds_read_b64_tr_b16 v[82:83], v6 offset:10752
    v_mfma_f32_32x32x16_bf16 v[176:191], v[48:51], v[32:35], v[176:191]
    ds_read_b64_tr_b16 v[84:85], v5 offset:18432
    ds_read_b64_tr_b16 v[86:87], v5 offset:18944
    v_mfma_f32_32x32x16_bf16 v[192:207], v[52:55], v[32:35], v[192:207]
    s_waitcnt lgkmcnt(0)
    v_mfma_f32_32x32x16_bf16 v[128:143], v[68:71], v[64:67], v[128:143]
    ds_read_b128 v[32:35], v3
    ds_read_b64_tr_b16 v[36:37], v5 offset:4096
    ds_read_b64_tr_b16 v[38:39], v5 offset:4608
    v_mfma_f32_32x32x16_bf16 v[144:159], v[72:75], v[64:67], v[144:159]
    ds_read_b64_tr_b16 v[40:41], v6 offset:4096
    ds_read_b64_tr_b16 v[42:43], v6 offset:4608
    ds_read_b64_tr_b16 v[44:45], v5 offset:12288
    v_mfma_f32_32x32x16_bf16 v[160:175], v[76:79], v[64:67], v[160:175]
    ds_read_b64_tr_b16 v[46:47], v5 offset:12800
    ds_read_b64_tr_b16 v[48:49], v6 offset:12288
    ds_read_b64_tr_b16 v[50:51], v6 offset:12800
    v_mfma_f32_32x32x16_bf16 v[176:191], v[80:83], v[64:67], v[176:191]
    ds_read_b64_tr_b16 v[52:53], v5 offset:20480
    ds_read_b64_tr_b16 v[54:55], v5 offset:20992
    v_mfma_f32_32x32x16_bf16 v[192:207], v[84:87], v[64:67], v[192:207]
    s_waitcnt lgkmcnt(0)
    v_mfma_f32_32x32x16_bf16 v[128:143], v[36:39], v[32:35], v[128:143]
    ds_read_b128 v[64:67], v4
    ds_read_b64_tr_b16 v[68:69], v5 offset:6144
    ds_read_b64_tr_b16 v[70:71], v5 offset:6656
    v_mfma_f32_32x32x16_bf16 v[144:159], v[40:43], v[32:35], v[144:159]
    ds_read_b64_tr_b16 v[72:73], v6 offset:6144
    ds_read_b64_tr_b16 v[74:75], v6 offset:6656
    ds_read_b64_tr_b16 v[76:77], v5 offset:14336
    v_mfma_f32_32x32x16_bf16 v[160:175], v[44:47], v[32:35], v[160:175]
    ds_read_b64_tr_b16 v[78:79], v5 offset:14848
    ds_read_b64_tr_b16 v[80:81], v6 offset:14336
    ds_read_b64_tr_b16 v[82:83], v6 offset:14848
    v_mfma_f32_32x32x16_bf16 v[176:191], v[48:51], v[32:35], v[176:191]
    ds_read_b64_tr_b16 v[84:85], v5 offset:22528
    ds_read_b64_tr_b16 v[86:87], v5 offset:23040
    v_mfma_f32_32x32x16_bf16 v[192:207], v[52:55], v[32:35], v[192:207]
    s_waitcnt lgkmcnt(0)
    v_mfma_f32_32x32x16_bf16 v[128:143], v[68:71], v[64:67], v[128:143]
    s_barrier
    s_add_u32 s60, s60, 43008
    s_cmp_eq_u32 s60, 129024
    s_cselect_b32 s60, 0, s60
    v_mfma_f32_32x32x16_bf16 v[144:159], v[72:75], v[64:67], v[144:159]
    v_add_u32 v1, s60, v8
    v_add_u32 v2, s60, v9
    v_add_u32 v3, s60, v10
    v_add_u32 v4, s60, v11
    v_add_u32 v5, s60, v12
    v_add_u32 v6, s60, v13
    v_mfma_f32_32x32x16_bf16 v[160:175], v[76:79], v[64:67], v[160:175]
    ds_read_b128 v[32:35], v1
    ds_read_b64_tr_b16 v[36:37], v5 offset:0
    ds_read_b64_tr_b16 v[38:39], v5 offset:512
    ds_read_b64_tr_b16 v[40:41], v6 offset:0
    v_mfma_f32_32x32x16_bf16 v[176:191], v[80:83], v[64:67], v[176:191]
    ds_read_b64_tr_b16 v[42:43], v6 offset:512
    ds_read_b64_tr_b16 v[44:45], v5 offset:8192
    ds_read_b64_tr_b16 v[46:47], v5 offset:8704
    ds_read_b64_tr_b16 v[48:49], v6 offset:8192
    v_mfma_f32_32x32x16_bf16 v[192:207], v[84:87], v[64:67], v[192:207]
    ds_read_b64_tr_b16 v[50:51], v6 offset:8704
    ds_read_b64_tr_b16 v[52:53], v5 offset:16384
    ds_read_b64_tr_b16 v[54:55], v5 offset:16896
    s_and_b32 s13, s78, 2
    s_cbranch_scc0 Lmsp_73
    s_nop 2
    v_mov_b32 v214, 163660
    ds_read_b32 v214, v214
    s_waitcnt lgkmcnt(0)
    v_readfirstlane_b32 s13, v214
    s_nop 0
    s_cmp_eq_u32 s13, 0
    s_cbranch_scc1 Lmsp_73
    s_andn2_b32 s78, s78, 2
    v_add_f32 v208, v208, v209
    v_add_f32 v209, v210, v211
    v_mov_b32 v210, v208
    v_mov_b32 v211, v209
    s_nop 0
    v_permlane32_swap_b32 v208, v210
    v_permlane32_swap_b32 v209, v211
    v_add_f32 v208, v208, v210
    v_add_f32 v209, v209, v211
    v_and_b32 v212, 31, v0
    s_lshl_b32 s13, s9, 7
    s_lshl_b32 s14, s8, 5
    s_add_u32 s13, s13, s14
    v_add_u32 v212, s13, v212
    v_lshlrev_b32 v212, 4, v212
    s_sub_u32 s13, s76, 3
    s_lshl_b32 s13, s13, 15
    s_add_u32 s13, s13, 7864320
    v_add_u32 v212, s13, v212
    v_mov_b32 v210, v209
    v_mov_b32 v209, v214
    v_mov_b32 v211, v214
    s_mov_b64 s[90:91], exec
    s_mov_b32 exec_hi, 0
    global_store_dwordx4 v212, v[208:211], s[36:37] sc1
    s_mov_b64 exec, s[90:91]
Lmsp_73:
    s_sub_u32 s63, s63, 1
    s_cmp_lg_u32 s63, 0
    s_cbranch_scc1 Lmloop_72
    s_waitcnt lgkmcnt(0)
    s_waitcnt vmcnt(0)
    v_mov_b32 v14, 163648
    s_mov_b32 s95, 0
Lwst_74:
    ds_read_b32 v15, v14
    ds_read_b32 v8, v14 offset:4
    ds_read_b32 v9, v14 offset:8
    s_waitcnt lgkmcnt(0)
    v_add3_u32 v15, v15, v8, v9
    s_nop 0
    v_readfirstlane_b32 s94, v15
    s_nop 0
    s_cmp_eq_u32 s94, 3
    s_cbranch_scc1 Lwsd_75
    s_add_u32 s95, s95, 1
    s_cmp_gt_u32 s95, 8388608
    s_cbranch_scc1 Lwsd_75
    s_sleep 1
    s_branch Lwst_74
Lwsd_75:
    v_and_b32 v14, 31, v0
    v_lshrrev_b32 v15, 5, v0
    s_lshl_b32 s13, s8, 5
    s_add_u32 s13, s13, 16
    v_add_u32 v16, s13, v14
    v_lshlrev_b32 v16, 3, v16
    v_add_u32 v16, 155648, v16
    ds_read_b64 v[2:3], v16
    v_lshlrev_b32 v17, 5, v15
    v_add_u32 v17, 157952, v17
    v_mov_b32 v4, 0xc0135761
    v_mov_b32 v5, 0xc0135761
    v_mov_b32 v20, 1.0
    v_mov_b32 v21, 1.0
    s_mov_b32 s68, 0xbdd2d3e8
    s_mov_b32 s69, 0xbdd2d3e8
    s_lshl_b32 s13, s9, 2
    s_add_u32 s13, s13, s8
    s_mul_i32 s13, s13, 118
    s_lshl_b32 s14, s12, 1
    s_add_u32 s13, s13, s14
    s_add_u32 s13, s13, 32
    s_lshl_b32 s13, s13, 10
    v_lshlrev_b32 v18, 4, v0
    v_add_u32 v18, s13, v18
    ds_read_b128 v[32:35], v17 offset:0
    ds_read_b128 v[48:51], v17 offset:768
    ds_read_b128 v[36:39], v17 offset:16
    ds_read_b128 v[52:55], v17 offset:784
    ds_read_b128 v[40:43], v17 offset:64
    ds_read_b128 v[56:59], v17 offset:832
    ds_read_b128 v[44:47], v17 offset:80
    ds_read_b128 v[60:63], v17 offset:848
    ds_read_b128 v[64:67], v17 offset:128
    ds_read_b128 v[80:83], v17 offset:896
    ds_read_b128 v[68:71], v17 offset:144
    ds_read_b128 v[84:87], v17 offset:912
    ds_read_b128 v[72:75], v17 offset:192
    ds_read_b128 v[88:91], v17 offset:960
    ds_read_b128 v[76:79], v17 offset:208
    ds_read_b128 v[92:95], v17 offset:976
    s_waitcnt lgkmcnt(14)
    v_pk_fma_f32 v[112:113], v[32:33], v[2:3], v[48:49] op_sel:[0,1,0] op_sel_hi:[1,1,1] neg_lo:[0,1,0] neg_hi:[0,1,0]
    v_pk_fma_f32 v[114:115], v[34:35], v[2:3], v[50:51] op_sel:[0,1,0] op_sel_hi:[1,1,1] neg_lo:[0,1,0] neg_hi:[0,1,0]
    s_waitcnt lgkmcnt(12)
    v_pk_fma_f32 v[116:117], v[36:37], v[2:3], v[52:53] op_sel:[0,1,0] op_sel_hi:[1,1,1] neg_lo:[0,1,0] neg_hi:[0,1,0]
    v_pk_fma_f32 v[118:119], v[38:39], v[2:3], v[54:55] op_sel:[0,1,0] op_sel_hi:[1,1,1] neg_lo:[0,1,0] neg_hi:[0,1,0]
    s_waitcnt lgkmcnt(10)
    v_pk_fma_f32 v[120:121], v[40:41], v[2:3], v[56:57] op_sel:[0,1,0] op_sel_hi:[1,1,1] neg_lo:[0,1,0] neg_hi:[0,1,0]
    v_pk_fma_f32 v[122:123], v[42:43], v[2:3], v[58:59] op_sel:[0,1,0] op_sel_hi:[1,1,1] neg_lo:[0,1,0] neg_hi:[0,1,0]
    s_waitcnt lgkmcnt(8)
    v_pk_fma_f32 v[124:125], v[44:45], v[2:3], v[60:61] op_sel:[0,1,0] op_sel_hi:[1,1,1] neg_lo:[0,1,0] neg_hi:[0,1,0]
    v_pk_fma_f32 v[126:127], v[46:47], v[2:3], v[62:63] op_sel:[0,1,0] op_sel_hi:[1,1,1] neg_lo:[0,1,0] neg_hi:[0,1,0]
    v_pk_fma_f32 v[128:129], v[128:129], v[2:3], v[112:113] op_sel_hi:[1,0,1]
    v_pk_fma_f32 v[130:131], v[130:131], v[2:3], v[114:115] op_sel_hi:[1,0,1]
    v_pk_fma_f32 v[132:133], v[132:133], v[2:3], v[116:117] op_sel_hi:[1,0,1]
    v_pk_fma_f32 v[134:135], v[134:135], v[2:3], v[118:119] op_sel_hi:[1,0,1]
    v_pk_fma_f32 v[136:137], v[136:137], v[2:3], v[120:121] op_sel_hi:[1,0,1]
    v_pk_fma_f32 v[138:139], v[138:139], v[2:3], v[122:123] op_sel_hi:[1,0,1]
    v_pk_fma_f32 v[140:141], v[140:141], v[2:3], v[124:125] op_sel_hi:[1,0,1]
    v_pk_fma_f32 v[142:143], v[142:143], v[2:3], v[126:127] op_sel_hi:[1,0,1]
    v_pk_mul_f32 v[112:113], v[128:129], v[128:129]
    v_pk_mul_f32 v[114:115], v[130:131], v[130:131]
    v_pk_mul_f32 v[116:117], v[132:133], v[132:133]
    v_pk_mul_f32 v[118:119], v[134:135], v[134:135]
    v_pk_mul_f32 v[120:121], v[136:137], v[136:137]
    v_pk_mul_f32 v[122:123], v[138:139], v[138:139]
    v_pk_mul_f32 v[124:125], v[140:141], v[140:141]
    v_pk_mul_f32 v[126:127], v[142:143], v[142:143]
    v_pk_fma_f32 v[112:113], v[112:113], s[68:69], v[4:5]
    v_pk_fma_f32 v[114:115], v[114:115], s[68:69], v[4:5]
    v_pk_fma_f32 v[116:117], v[116:117], s[68:69], v[4:5]
    v_pk_fma_f32 v[118:119], v[118:119], s[68:69], v[4:5]
    v_pk_fma_f32 v[120:121], v[120:121], s[68:69], v[4:5]
    v_pk_fma_f32 v[122:123], v[122:123], s[68:69], v[4:5]
    v_pk_fma_f32 v[124:125], v[124:125], s[68:69], v[4:5]
    v_pk_fma_f32 v[126:127], v[126:127], s[68:69], v[4:5]
    v_pk_mul_f32 v[112:113], v[112:113], v[128:129]
    v_pk_mul_f32 v[114:115], v[114:115], v[130:131]
    v_pk_mul_f32 v[116:117], v[116:117], v[132:133]
    v_pk_mul_f32 v[118:119], v[118:119], v[134:135]
    v_pk_mul_f32 v[120:121], v[120:121], v[136:137]
    v_pk_mul_f32 v[122:123], v[122:123], v[138:139]
    v_pk_mul_f32 v[124:125], v[124:125], v[140:141]
    v_pk_mul_f32 v[126:127], v[126:127], v[142:143]
    v_exp_f32 v112, v112
    v_exp_f32 v114, v114
    v_exp_f32 v116, v116
    v_exp_f32 v118, v118
    v_exp_f32 v120, v120
    v_exp_f32 v122, v122
    v_exp_f32 v124, v124
    v_exp_f32 v126, v126
    v_exp_f32 v113, v113
    v_exp_f32 v115, v115
    v_exp_f32 v117, v117
    v_exp_f32 v119, v119
    v_exp_f32 v121, v121
    v_exp_f32 v123, v123
    v_exp_f32 v125, v125
    v_exp_f32 v127, v127
    v_pk_add_f32 v[112:113], v[112:113], v[20:21]
    v_pk_add_f32 v[114:115], v[114:115], v[20:21]
    v_pk_add_f32 v[116:117], v[116:117], v[20:21]
    v_pk_add_f32 v[118:119], v[118:119], v[20:21]
    v_pk_add_f32 v[120:121], v[120:121], v[20:21]
    v_pk_add_f32 v[122:123], v[122:123], v[20:21]
    v_pk_add_f32 v[124:125], v[124:125], v[20:21]
    v_pk_add_f32 v[126:127], v[126:127], v[20:21]
    v_rcp_f32 v112, v112
    v_rcp_f32 v114, v114
    v_rcp_f32 v116, v116
    v_rcp_f32 v118, v118
    v_rcp_f32 v120, v120
    v_rcp_f32 v122, v122
    v_rcp_f32 v124, v124
    v_rcp_f32 v126, v126
    v_rcp_f32 v113, v113
    v_rcp_f32 v115, v115
    v_rcp_f32 v117, v117
    v_rcp_f32 v119, v119
    v_rcp_f32 v121, v121
    v_rcp_f32 v123, v123
    v_rcp_f32 v125, v125
    v_rcp_f32 v127, v127
    v_pk_mul_f32 v[112:113], v[112:113], v[128:129]
    v_pk_mul_f32 v[114:115], v[114:115], v[130:131]
    v_pk_mul_f32 v[116:117], v[116:117], v[132:133]
    v_pk_mul_f32 v[118:119], v[118:119], v[134:135]
    v_pk_mul_f32 v[120:121], v[120:121], v[136:137]
    v_pk_mul_f32 v[122:123], v[122:123], v[138:139]
    v_pk_mul_f32 v[124:125], v[124:125], v[140:141]
    v_pk_mul_f32 v[126:127], v[126:127], v[142:143]
    v_cvt_pk_bf16_f32 v96, v112, v113
    v_cvt_pk_bf16_f32 v102, v124, v125
    v_cvt_pk_bf16_f32 v97, v114, v115
    v_cvt_pk_bf16_f32 v99, v118, v119
    v_cvt_pk_bf16_f32 v98, v116, v117
    v_cvt_pk_bf16_f32 v100, v120, v121
    v_cvt_pk_bf16_f32 v101, v122, v123
    v_cvt_pk_bf16_f32 v103, v126, v127
    global_store_dwordx4 v18, v[96:99], s[36:37] sc1
    global_store_dwordx4 v18, v[100:103], s[36:37] offset:1024 sc1
    s_nop 1
    v_add_u32 v18, 2048, v18
    ds_read_b128 v[32:35], v17 offset:256
    ds_read_b128 v[48:51], v17 offset:1024
    ds_read_b128 v[36:39], v17 offset:272
    ds_read_b128 v[52:55], v17 offset:1040
    ds_read_b128 v[40:43], v17 offset:320
    ds_read_b128 v[56:59], v17 offset:1088
    ds_read_b128 v[44:47], v17 offset:336
    ds_read_b128 v[60:63], v17 offset:1104
    s_waitcnt lgkmcnt(14)
    v_pk_fma_f32 v[112:113], v[64:65], v[2:3], v[80:81] op_sel:[0,1,0] op_sel_hi:[1,1,1] neg_lo:[0,1,0] neg_hi:[0,1,0]
    v_pk_fma_f32 v[114:115], v[66:67], v[2:3], v[82:83] op_sel:[0,1,0] op_sel_hi:[1,1,1] neg_lo:[0,1,0] neg_hi:[0,1,0]
    s_waitcnt lgkmcnt(12)
    v_pk_fma_f32 v[116:117], v[68:69], v[2:3], v[84:85] op_sel:[0,1,0] op_sel_hi:[1,1,1] neg_lo:[0,1,0] neg_hi:[0,1,0]
    v_pk_fma_f32 v[118:119], v[70:71], v[2:3], v[86:87] op_sel:[0,1,0] op_sel_hi:[1,1,1] neg_lo:[0,1,0] neg_hi:[0,1,0]
    s_waitcnt lgkmcnt(10)
    v_pk_fma_f32 v[120:121], v[72:73], v[2:3], v[88:89] op_sel:[0,1,0] op_sel_hi:[1,1,1] neg_lo:[0,1,0] neg_hi:[0,1,0]
    v_pk_fma_f32 v[122:123], v[74:75], v[2:3], v[90:91] op_sel:[0,1,0] op_sel_hi:[1,1,1] neg_lo:[0,1,0] neg_hi:[0,1,0]
    s_waitcnt lgkmcnt(8)
    v_pk_fma_f32 v[124:125], v[76:77], v[2:3], v[92:93] op_sel:[0,1,0] op_sel_hi:[1,1,1] neg_lo:[0,1,0] neg_hi:[0,1,0]
    v_pk_fma_f32 v[126:127], v[78:79], v[2:3], v[94:95] op_sel:[0,1,0] op_sel_hi:[1,1,1] neg_lo:[0,1,0] neg_hi:[0,1,0]
    v_pk_fma_f32 v[144:145], v[144:145], v[2:3], v[112:113] op_sel_hi:[1,0,1]
    v_pk_fma_f32 v[146:147], v[146:147], v[2:3], v[114:115] op_sel_hi:[1,0,1]
    v_pk_fma_f32 v[148:149], v[148:149], v[2:3], v[116:117] op_sel_hi:[1,0,1]
    v_pk_fma_f32 v[150:151], v[150:151], v[2:3], v[118:119] op_sel_hi:[1,0,1]
    v_pk_fma_f32 v[152:153], v[152:153], v[2:3], v[120:121] op_sel_hi:[1,0,1]
    v_pk_fma_f32 v[154:155], v[154:155], v[2:3], v[122:123] op_sel_hi:[1,0,1]
    v_pk_fma_f32 v[156:157], v[156:157], v[2:3], v[124:125] op_sel_hi:[1,0,1]
    v_pk_fma_f32 v[158:159], v[158:159], v[2:3], v[126:127] op_sel_hi:[1,0,1]
    v_pk_mul_f32 v[112:113], v[144:145], v[144:145]
    v_pk_mul_f32 v[114:115], v[146:147], v[146:147]
    v_pk_mul_f32 v[116:117], v[148:149], v[148:149]
    v_pk_mul_f32 v[118:119], v[150:151], v[150:151]
    v_pk_mul_f32 v[120:121], v[152:153], v[152:153]
    v_pk_mul_f32 v[122:123], v[154:155], v[154:155]
    v_pk_mul_f32 v[124:125], v[156:157], v[156:157]
    v_pk_mul_f32 v[126:127], v[158:159], v[158:159]
    v_pk_fma_f32 v[112:113], v[112:113], s[68:69], v[4:5]
    v_pk_fma_f32 v[114:115], v[114:115], s[68:69], v[4:5]
    v_pk_fma_f32 v[116:117], v[116:117], s[68:69], v[4:5]
    v_pk_fma_f32 v[118:119], v[118:119], s[68:69], v[4:5]
    v_pk_fma_f32 v[120:121], v[120:121], s[68:69], v[4:5]
    v_pk_fma_f32 v[122:123], v[122:123], s[68:69], v[4:5]
    v_pk_fma_f32 v[124:125], v[124:125], s[68:69], v[4:5]
    v_pk_fma_f32 v[126:127], v[126:127], s[68:69], v[4:5]
    v_pk_mul_f32 v[112:113], v[112:113], v[144:145]
    v_pk_mul_f32 v[114:115], v[114:115], v[146:147]
    v_pk_mul_f32 v[116:117], v[116:117], v[148:149]
    v_pk_mul_f32 v[118:119], v[118:119], v[150:151]
    v_pk_mul_f32 v[120:121], v[120:121], v[152:153]
    v_pk_mul_f32 v[122:123], v[122:123], v[154:155]
    v_pk_mul_f32 v[124:125], v[124:125], v[156:157]
    v_pk_mul_f32 v[126:127], v[126:127], v[158:159]
    v_exp_f32 v112, v112
    v_exp_f32 v114, v114
    v_exp_f32 v116, v116
    v_exp_f32 v118, v118
    v_exp_f32 v120, v120
    v_exp_f32 v122, v122
    v_exp_f32 v124, v124
    v_exp_f32 v126, v126
    v_exp_f32 v113, v113
    v_exp_f32 v115, v115
    v_exp_f32 v117, v117
    v_exp_f32 v119, v119
    v_exp_f32 v121, v121
    v_exp_f32 v123, v123
    v_exp_f32 v125, v125
    v_exp_f32 v127, v127
    v_pk_add_f32 v[112:113], v[112:113], v[20:21]
    v_pk_add_f32 v[114:115], v[114:115], v[20:21]
    v_pk_add_f32 v[116:117], v[116:117], v[20:21]
    v_pk_add_f32 v[118:119], v[118:119], v[20:21]
    v_pk_add_f32 v[120:121], v[120:121], v[20:21]
    v_pk_add_f32 v[122:123], v[122:123], v[20:21]
    v_pk_add_f32 v[124:125], v[124:125], v[20:21]
    v_pk_add_f32 v[126:127], v[126:127], v[20:21]
    v_rcp_f32 v112, v112
    v_rcp_f32 v114, v114
    v_rcp_f32 v116, v116
    v_rcp_f32 v118, v118
    v_rcp_f32 v120, v120
    v_rcp_f32 v122, v122
    v_rcp_f32 v124, v124
    v_rcp_f32 v126, v126
    v_rcp_f32 v113, v113
    v_rcp_f32 v115, v115
    v_rcp_f32 v117, v117
    v_rcp_f32 v119, v119
    v_rcp_f32 v121, v121
    v_rcp_f32 v123, v123
    v_rcp_f32 v125, v125
    v_rcp_f32 v127, v127
    v_pk_mul_f32 v[112:113], v[112:113], v[144:145]
    v_pk_mul_f32 v[114:115], v[114:115], v[146:147]
    v_pk_mul_f32 v[116:117], v[116:117], v[148:149]
    v_pk_mul_f32 v[118:119], v[118:119], v[150:151]
    v_pk_mul_f32 v[120:121], v[120:121], v[152:153]
    v_pk_mul_f32 v[122:123], v[122:123], v[154:155]
    v_pk_mul_f32 v[124:125], v[124:125], v[156:157]
    v_pk_mul_f32 v[126:127], v[126:127], v[158:159]
    v_cvt_pk_bf16_f32 v104, v112, v113
    v_cvt_pk_bf16_f32 v110, v124, v125
    v_cvt_pk_bf16_f32 v105, v114, v115
    v_cvt_pk_bf16_f32 v107, v118, v119
    v_cvt_pk_bf16_f32 v106, v116, v117
    v_cvt_pk_bf16_f32 v108, v120, v121
    v_cvt_pk_bf16_f32 v109, v122, v123
    v_cvt_pk_bf16_f32 v111, v126, v127
    global_store_dwordx4 v18, v[104:107], s[36:37] sc1
    global_store_dwordx4 v18, v[108:111], s[36:37] offset:1024 sc1
    s_nop 1
    v_add_u32 v18, 2048, v18
    ds_read_b128 v[64:67], v17 offset:384
    ds_read_b128 v[80:83], v17 offset:1152
    ds_read_b128 v[68:71], v17 offset:400
    ds_read_b128 v[84:87], v17 offset:1168
    ds_read_b128 v[72:75], v17 offset:448
    ds_read_b128 v[88:91], v17 offset:1216
    ds_read_b128 v[76:79], v17 offset:464
    ds_read_b128 v[92:95], v17 offset:1232
    s_waitcnt lgkmcnt(14)
    v_pk_fma_f32 v[112:113], v[32:33], v[2:3], v[48:49] op_sel:[0,1,0] op_sel_hi:[1,1,1] neg_lo:[0,1,0] neg_hi:[0,1,0]
    v_pk_fma_f32 v[114:115], v[34:35], v[2:3], v[50:51] op_sel:[0,1,0] op_sel_hi:[1,1,1] neg_lo:[0,1,0] neg_hi:[0,1,0]
    s_waitcnt lgkmcnt(12)
    v_pk_fma_f32 v[116:117], v[36:37], v[2:3], v[52:53] op_sel:[0,1,0] op_sel_hi:[1,1,1] neg_lo:[0,1,0] neg_hi:[0,1,0]
    v_pk_fma_f32 v[118:119], v[38:39], v[2:3], v[54:55] op_sel:[0,1,0] op_sel_hi:[1,1,1] neg_lo:[0,1,0] neg_hi:[0,1,0]
    s_waitcnt lgkmcnt(10)
    v_pk_fma_f32 v[120:121], v[40:41], v[2:3], v[56:57] op_sel:[0,1,0] op_sel_hi:[1,1,1] neg_lo:[0,1,0] neg_hi:[0,1,0]
    v_pk_fma_f32 v[122:123], v[42:43], v[2:3], v[58:59] op_sel:[0,1,0] op_sel_hi:[1,1,1] neg_lo:[0,1,0] neg_hi:[0,1,0]
    s_waitcnt lgkmcnt(8)
    v_pk_fma_f32 v[124:125], v[44:45], v[2:3], v[60:61] op_sel:[0,1,0] op_sel_hi:[1,1,1] neg_lo:[0,1,0] neg_hi:[0,1,0]
    v_pk_fma_f32 v[126:127], v[46:47], v[2:3], v[62:63] op_sel:[0,1,0] op_sel_hi:[1,1,1] neg_lo:[0,1,0] neg_hi:[0,1,0]
    v_pk_fma_f32 v[160:161], v[160:161], v[2:3], v[112:113] op_sel_hi:[1,0,1]
    v_pk_fma_f32 v[162:163], v[162:163], v[2:3], v[114:115] op_sel_hi:[1,0,1]
    v_pk_fma_f32 v[164:165], v[164:165], v[2:3], v[116:117] op_sel_hi:[1,0,1]
    v_pk_fma_f32 v[166:167], v[166:167], v[2:3], v[118:119] op_sel_hi:[1,0,1]
    v_pk_fma_f32 v[168:169], v[168:169], v[2:3], v[120:121] op_sel_hi:[1,0,1]
    v_pk_fma_f32 v[170:171], v[170:171], v[2:3], v[122:123] op_sel_hi:[1,0,1]
    v_pk_fma_f32 v[172:173], v[172:173], v[2:3], v[124:125] op_sel_hi:[1,0,1]
    v_pk_fma_f32 v[174:175], v[174:175], v[2:3], v[126:127] op_sel_hi:[1,0,1]
    v_pk_mul_f32 v[112:113], v[160:161], v[160:161]
    v_pk_mul_f32 v[114:115], v[162:163], v[162:163]
    v_pk_mul_f32 v[116:117], v[164:165], v[164:165]
    v_pk_mul_f32 v[118:119], v[166:167], v[166:167]
    v_pk_mul_f32 v[120:121], v[168:169], v[168:169]
    v_pk_mul_f32 v[122:123], v[170:171], v[170:171]
    v_pk_mul_f32 v[124:125], v[172:173], v[172:173]
    v_pk_mul_f32 v[126:127], v[174:175], v[174:175]
    v_pk_fma_f32 v[112:113], v[112:113], s[68:69], v[4:5]
    v_pk_fma_f32 v[114:115], v[114:115], s[68:69], v[4:5]
    v_pk_fma_f32 v[116:117], v[116:117], s[68:69], v[4:5]
    v_pk_fma_f32 v[118:119], v[118:119], s[68:69], v[4:5]
    v_pk_fma_f32 v[120:121], v[120:121], s[68:69], v[4:5]
    v_pk_fma_f32 v[122:123], v[122:123], s[68:69], v[4:5]
    v_pk_fma_f32 v[124:125], v[124:125], s[68:69], v[4:5]
    v_pk_fma_f32 v[126:127], v[126:127], s[68:69], v[4:5]
    v_pk_mul_f32 v[112:113], v[112:113], v[160:161]
    v_pk_mul_f32 v[114:115], v[114:115], v[162:163]
    v_pk_mul_f32 v[116:117], v[116:117], v[164:165]
    v_pk_mul_f32 v[118:119], v[118:119], v[166:167]
    v_pk_mul_f32 v[120:121], v[120:121], v[168:169]
    v_pk_mul_f32 v[122:123], v[122:123], v[170:171]
    v_pk_mul_f32 v[124:125], v[124:125], v[172:173]
    v_pk_mul_f32 v[126:127], v[126:127], v[174:175]
    v_exp_f32 v112, v112
    v_exp_f32 v114, v114
    v_exp_f32 v116, v116
    v_exp_f32 v118, v118
    v_exp_f32 v120, v120
    v_exp_f32 v122, v122
    v_exp_f32 v124, v124
    v_exp_f32 v126, v126
    v_exp_f32 v113, v113
    v_exp_f32 v115, v115
    v_exp_f32 v117, v117
    v_exp_f32 v119, v119
    v_exp_f32 v121, v121
    v_exp_f32 v123, v123
    v_exp_f32 v125, v125
    v_exp_f32 v127, v127
    v_pk_add_f32 v[112:113], v[112:113], v[20:21]
    v_pk_add_f32 v[114:115], v[114:115], v[20:21]
    v_pk_add_f32 v[116:117], v[116:117], v[20:21]
    v_pk_add_f32 v[118:119], v[118:119], v[20:21]
    v_pk_add_f32 v[120:121], v[120:121], v[20:21]
    v_pk_add_f32 v[122:123], v[122:123], v[20:21]
    v_pk_add_f32 v[124:125], v[124:125], v[20:21]
    v_pk_add_f32 v[126:127], v[126:127], v[20:21]
    v_rcp_f32 v112, v112
    v_rcp_f32 v114, v114
    v_rcp_f32 v116, v116
    v_rcp_f32 v118, v118
    v_rcp_f32 v120, v120
    v_rcp_f32 v122, v122
    v_rcp_f32 v124, v124
    v_rcp_f32 v126, v126
    v_rcp_f32 v113, v113
    v_rcp_f32 v115, v115
    v_rcp_f32 v117, v117
    v_rcp_f32 v119, v119
    v_rcp_f32 v121, v121
    v_rcp_f32 v123, v123
    v_rcp_f32 v125, v125
    v_rcp_f32 v127, v127
    v_pk_mul_f32 v[112:113], v[112:113], v[160:161]
    v_pk_mul_f32 v[114:115], v[114:115], v[162:163]
    v_pk_mul_f32 v[116:117], v[116:117], v[164:165]
    v_pk_mul_f32 v[118:119], v[118:119], v[166:167]
    v_pk_mul_f32 v[120:121], v[120:121], v[168:169]
    v_pk_mul_f32 v[122:123], v[122:123], v[170:171]
    v_pk_mul_f32 v[124:125], v[124:125], v[172:173]
    v_pk_mul_f32 v[126:127], v[126:127], v[174:175]
    v_cvt_pk_bf16_f32 v96, v112, v113
    v_cvt_pk_bf16_f32 v102, v124, v125
    v_cvt_pk_bf16_f32 v97, v114, v115
    v_cvt_pk_bf16_f32 v99, v118, v119
    v_cvt_pk_bf16_f32 v98, v116, v117
    v_cvt_pk_bf16_f32 v100, v120, v121
    v_cvt_pk_bf16_f32 v101, v122, v123
    v_cvt_pk_bf16_f32 v103, v126, v127
    global_store_dwordx4 v18, v[96:99], s[36:37] sc1
    global_store_dwordx4 v18, v[100:103], s[36:37] offset:1024 sc1
    s_nop 1
    v_add_u32 v18, 2048, v18
    ds_read_b128 v[32:35], v17 offset:512
    ds_read_b128 v[48:51], v17 offset:1280
    ds_read_b128 v[36:39], v17 offset:528
    ds_read_b128 v[52:55], v17 offset:1296
    ds_read_b128 v[40:43], v17 offset:576
    ds_read_b128 v[56:59], v17 offset:1344
    ds_read_b128 v[44:47], v17 offset:592
    ds_read_b128 v[60:63], v17 offset:1360
    s_waitcnt lgkmcnt(14)
    v_pk_fma_f32 v[112:113], v[64:65], v[2:3], v[80:81] op_sel:[0,1,0] op_sel_hi:[1,1,1] neg_lo:[0,1,0] neg_hi:[0,1,0]
    v_pk_fma_f32 v[114:115], v[66:67], v[2:3], v[82:83] op_sel:[0,1,0] op_sel_hi:[1,1,1] neg_lo:[0,1,0] neg_hi:[0,1,0]
    s_waitcnt lgkmcnt(12)
    v_pk_fma_f32 v[116:117], v[68:69], v[2:3], v[84:85] op_sel:[0,1,0] op_sel_hi:[1,1,1] neg_lo:[0,1,0] neg_hi:[0,1,0]
    v_pk_fma_f32 v[118:119], v[70:71], v[2:3], v[86:87] op_sel:[0,1,0] op_sel_hi:[1,1,1] neg_lo:[0,1,0] neg_hi:[0,1,0]
    s_waitcnt lgkmcnt(10)
    v_pk_fma_f32 v[120:121], v[72:73], v[2:3], v[88:89] op_sel:[0,1,0] op_sel_hi:[1,1,1] neg_lo:[0,1,0] neg_hi:[0,1,0]
    v_pk_fma_f32 v[122:123], v[74:75], v[2:3], v[90:91] op_sel:[0,1,0] op_sel_hi:[1,1,1] neg_lo:[0,1,0] neg_hi:[0,1,0]
    s_waitcnt lgkmcnt(8)
    v_pk_fma_f32 v[124:125], v[76:77], v[2:3], v[92:93] op_sel:[0,1,0] op_sel_hi:[1,1,1] neg_lo:[0,1,0] neg_hi:[0,1,0]
    v_pk_fma_f32 v[126:127], v[78:79], v[2:3], v[94:95] op_sel:[0,1,0] op_sel_hi:[1,1,1] neg_lo:[0,1,0] neg_hi:[0,1,0]
    v_pk_fma_f32 v[176:177], v[176:177], v[2:3], v[112:113] op_sel_hi:[1,0,1]
    v_pk_fma_f32 v[178:179], v[178:179], v[2:3], v[114:115] op_sel_hi:[1,0,1]
    v_pk_fma_f32 v[180:181], v[180:181], v[2:3], v[116:117] op_sel_hi:[1,0,1]
    v_pk_fma_f32 v[182:183], v[182:183], v[2:3], v[118:119] op_sel_hi:[1,0,1]
    v_pk_fma_f32 v[184:185], v[184:185], v[2:3], v[120:121] op_sel_hi:[1,0,1]
    v_pk_fma_f32 v[186:187], v[186:187], v[2:3], v[122:123] op_sel_hi:[1,0,1]
    v_pk_fma_f32 v[188:189], v[188:189], v[2:3], v[124:125] op_sel_hi:[1,0,1]
    v_pk_fma_f32 v[190:191], v[190:191], v[2:3], v[126:127] op_sel_hi:[1,0,1]
    v_pk_mul_f32 v[112:113], v[176:177], v[176:177]
    v_pk_mul_f32 v[114:115], v[178:179], v[178:179]
    v_pk_mul_f32 v[116:117], v[180:181], v[180:181]
    v_pk_mul_f32 v[118:119], v[182:183], v[182:183]
    v_pk_mul_f32 v[120:121], v[184:185], v[184:185]
    v_pk_mul_f32 v[122:123], v[186:187], v[186:187]
    v_pk_mul_f32 v[124:125], v[188:189], v[188:189]
    v_pk_mul_f32 v[126:127], v[190:191], v[190:191]
    v_pk_fma_f32 v[112:113], v[112:113], s[68:69], v[4:5]
    v_pk_fma_f32 v[114:115], v[114:115], s[68:69], v[4:5]
    v_pk_fma_f32 v[116:117], v[116:117], s[68:69], v[4:5]
    v_pk_fma_f32 v[118:119], v[118:119], s[68:69], v[4:5]
    v_pk_fma_f32 v[120:121], v[120:121], s[68:69], v[4:5]
    v_pk_fma_f32 v[122:123], v[122:123], s[68:69], v[4:5]
    v_pk_fma_f32 v[124:125], v[124:125], s[68:69], v[4:5]
    v_pk_fma_f32 v[126:127], v[126:127], s[68:69], v[4:5]
    v_pk_mul_f32 v[112:113], v[112:113], v[176:177]
    v_pk_mul_f32 v[114:115], v[114:115], v[178:179]
    v_pk_mul_f32 v[116:117], v[116:117], v[180:181]
    v_pk_mul_f32 v[118:119], v[118:119], v[182:183]
    v_pk_mul_f32 v[120:121], v[120:121], v[184:185]
    v_pk_mul_f32 v[122:123], v[122:123], v[186:187]
    v_pk_mul_f32 v[124:125], v[124:125], v[188:189]
    v_pk_mul_f32 v[126:127], v[126:127], v[190:191]
    v_exp_f32 v112, v112
    v_exp_f32 v114, v114
    v_exp_f32 v116, v116
    v_exp_f32 v118, v118
    v_exp_f32 v120, v120
    v_exp_f32 v122, v122
    v_exp_f32 v124, v124
    v_exp_f32 v126, v126
    v_exp_f32 v113, v113
    v_exp_f32 v115, v115
    v_exp_f32 v117, v117
    v_exp_f32 v119, v119
    v_exp_f32 v121, v121
    v_exp_f32 v123, v123
    v_exp_f32 v125, v125
    v_exp_f32 v127, v127
    v_pk_add_f32 v[112:113], v[112:113], v[20:21]
    v_pk_add_f32 v[114:115], v[114:115], v[20:21]
    v_pk_add_f32 v[116:117], v[116:117], v[20:21]
    v_pk_add_f32 v[118:119], v[118:119], v[20:21]
    v_pk_add_f32 v[120:121], v[120:121], v[20:21]
    v_pk_add_f32 v[122:123], v[122:123], v[20:21]
    v_pk_add_f32 v[124:125], v[124:125], v[20:21]
    v_pk_add_f32 v[126:127], v[126:127], v[20:21]
    v_rcp_f32 v112, v112
    v_rcp_f32 v114, v114
    v_rcp_f32 v116, v116
    v_rcp_f32 v118, v118
    v_rcp_f32 v120, v120
    v_rcp_f32 v122, v122
    v_rcp_f32 v124, v124
    v_rcp_f32 v126, v126
    v_rcp_f32 v113, v113
    v_rcp_f32 v115, v115
    v_rcp_f32 v117, v117
    v_rcp_f32 v119, v119
    v_rcp_f32 v121, v121
    v_rcp_f32 v123, v123
    v_rcp_f32 v125, v125
    v_rcp_f32 v127, v127
    v_pk_mul_f32 v[112:113], v[112:113], v[176:177]
    v_pk_mul_f32 v[114:115], v[114:115], v[178:179]
    v_pk_mul_f32 v[116:117], v[116:117], v[180:181]
    v_pk_mul_f32 v[118:119], v[118:119], v[182:183]
    v_pk_mul_f32 v[120:121], v[120:121], v[184:185]
    v_pk_mul_f32 v[122:123], v[122:123], v[186:187]
    v_pk_mul_f32 v[124:125], v[124:125], v[188:189]
    v_pk_mul_f32 v[126:127], v[126:127], v[190:191]
    v_cvt_pk_bf16_f32 v104, v112, v113
    v_cvt_pk_bf16_f32 v110, v124, v125
    v_cvt_pk_bf16_f32 v105, v114, v115
    v_cvt_pk_bf16_f32 v107, v118, v119
    v_cvt_pk_bf16_f32 v106, v116, v117
    v_cvt_pk_bf16_f32 v108, v120, v121
    v_cvt_pk_bf16_f32 v109, v122, v123
    v_cvt_pk_bf16_f32 v111, v126, v127
    global_store_dwordx4 v18, v[104:107], s[36:37] sc1
    global_store_dwordx4 v18, v[108:111], s[36:37] offset:1024 sc1
    s_nop 1
    v_add_u32 v18, 2048, v18
    s_waitcnt lgkmcnt(6)
    v_pk_fma_f32 v[112:113], v[32:33], v[2:3], v[48:49] op_sel:[0,1,0] op_sel_hi:[1,1,1] neg_lo:[0,1,0] neg_hi:[0,1,0]
    v_pk_fma_f32 v[114:115], v[34:35], v[2:3], v[50:51] op_sel:[0,1,0] op_sel_hi:[1,1,1] neg_lo:[0,1,0] neg_hi:[0,1,0]
    s_waitcnt lgkmcnt(4)
    v_pk_fma_f32 v[116:117], v[36:37], v[2:3], v[52:53] op_sel:[0,1,0] op_sel_hi:[1,1,1] neg_lo:[0,1,0] neg_hi:[0,1,0]
    v_pk_fma_f32 v[118:119], v[38:39], v[2:3], v[54:55] op_sel:[0,1,0] op_sel_hi:[1,1,1] neg_lo:[0,1,0] neg_hi:[0,1,0]
    s_waitcnt lgkmcnt(2)
    v_pk_fma_f32 v[120:121], v[40:41], v[2:3], v[56:57] op_sel:[0,1,0] op_sel_hi:[1,1,1] neg_lo:[0,1,0] neg_hi:[0,1,0]
    v_pk_fma_f32 v[122:123], v[42:43], v[2:3], v[58:59] op_sel:[0,1,0] op_sel_hi:[1,1,1] neg_lo:[0,1,0] neg_hi:[0,1,0]
    s_waitcnt lgkmcnt(0)
    v_pk_fma_f32 v[124:125], v[44:45], v[2:3], v[60:61] op_sel:[0,1,0] op_sel_hi:[1,1,1] neg_lo:[0,1,0] neg_hi:[0,1,0]
    v_pk_fma_f32 v[126:127], v[46:47], v[2:3], v[62:63] op_sel:[0,1,0] op_sel_hi:[1,1,1] neg_lo:[0,1,0] neg_hi:[0,1,0]
    v_pk_fma_f32 v[192:193], v[192:193], v[2:3], v[112:113] op_sel_hi:[1,0,1]
    v_pk_fma_f32 v[194:195], v[194:195], v[2:3], v[114:115] op_sel_hi:[1,0,1]
    v_pk_fma_f32 v[196:197], v[196:197], v[2:3], v[116:117] op_sel_hi:[1,0,1]
    v_pk_fma_f32 v[198:199], v[198:199], v[2:3], v[118:119] op_sel_hi:[1,0,1]
    v_pk_fma_f32 v[200:201], v[200:201], v[2:3], v[120:121] op_sel_hi:[1,0,1]
    v_pk_fma_f32 v[202:203], v[202:203], v[2:3], v[122:123] op_sel_hi:[1,0,1]
    v_pk_fma_f32 v[204:205], v[204:205], v[2:3], v[124:125] op_sel_hi:[1,0,1]
    v_pk_fma_f32 v[206:207], v[206:207], v[2:3], v[126:127] op_sel_hi:[1,0,1]
    v_pk_mul_f32 v[112:113], v[192:193], v[192:193]
    v_pk_mul_f32 v[114:115], v[194:195], v[194:195]
    v_pk_mul_f32 v[116:117], v[196:197], v[196:197]
    v_pk_mul_f32 v[118:119], v[198:199], v[198:199]
    v_pk_mul_f32 v[120:121], v[200:201], v[200:201]
    v_pk_mul_f32 v[122:123], v[202:203], v[202:203]
    v_pk_mul_f32 v[124:125], v[204:205], v[204:205]
    v_pk_mul_f32 v[126:127], v[206:207], v[206:207]
    v_pk_fma_f32 v[112:113], v[112:113], s[68:69], v[4:5]
    v_pk_fma_f32 v[114:115], v[114:115], s[68:69], v[4:5]
    v_pk_fma_f32 v[116:117], v[116:117], s[68:69], v[4:5]
    v_pk_fma_f32 v[118:119], v[118:119], s[68:69], v[4:5]
    v_pk_fma_f32 v[120:121], v[120:121], s[68:69], v[4:5]
    v_pk_fma_f32 v[122:123], v[122:123], s[68:69], v[4:5]
    v_pk_fma_f32 v[124:125], v[124:125], s[68:69], v[4:5]
    v_pk_fma_f32 v[126:127], v[126:127], s[68:69], v[4:5]
    v_pk_mul_f32 v[112:113], v[112:113], v[192:193]
    v_pk_mul_f32 v[114:115], v[114:115], v[194:195]
    v_pk_mul_f32 v[116:117], v[116:117], v[196:197]
    v_pk_mul_f32 v[118:119], v[118:119], v[198:199]
    v_pk_mul_f32 v[120:121], v[120:121], v[200:201]
    v_pk_mul_f32 v[122:123], v[122:123], v[202:203]
    v_pk_mul_f32 v[124:125], v[124:125], v[204:205]
    v_pk_mul_f32 v[126:127], v[126:127], v[206:207]
    v_exp_f32 v112, v112
    v_exp_f32 v114, v114
    v_exp_f32 v116, v116
    v_exp_f32 v118, v118
    v_exp_f32 v120, v120
    v_exp_f32 v122, v122
    v_exp_f32 v124, v124
    v_exp_f32 v126, v126
    v_exp_f32 v113, v113
    v_exp_f32 v115, v115
    v_exp_f32 v117, v117
    v_exp_f32 v119, v119
    v_exp_f32 v121, v121
    v_exp_f32 v123, v123
    v_exp_f32 v125, v125
    v_exp_f32 v127, v127
    v_pk_add_f32 v[112:113], v[112:113], v[20:21]
    v_pk_add_f32 v[114:115], v[114:115], v[20:21]
    v_pk_add_f32 v[116:117], v[116:117], v[20:21]
    v_pk_add_f32 v[118:119], v[118:119], v[20:21]
    v_pk_add_f32 v[120:121], v[120:121], v[20:21]
    v_pk_add_f32 v[122:123], v[122:123], v[20:21]
    v_pk_add_f32 v[124:125], v[124:125], v[20:21]
    v_pk_add_f32 v[126:127], v[126:127], v[20:21]
    v_rcp_f32 v112, v112
    v_rcp_f32 v114, v114
    v_rcp_f32 v116, v116
    v_rcp_f32 v118, v118
    v_rcp_f32 v120, v120
    v_rcp_f32 v122, v122
    v_rcp_f32 v124, v124
    v_rcp_f32 v126, v126
    v_rcp_f32 v113, v113
    v_rcp_f32 v115, v115
    v_rcp_f32 v117, v117
    v_rcp_f32 v119, v119
    v_rcp_f32 v121, v121
    v_rcp_f32 v123, v123
    v_rcp_f32 v125, v125
    v_rcp_f32 v127, v127
    v_pk_mul_f32 v[112:113], v[112:113], v[192:193]
    v_pk_mul_f32 v[114:115], v[114:115], v[194:195]
    v_pk_mul_f32 v[116:117], v[116:117], v[196:197]
    v_pk_mul_f32 v[118:119], v[118:119], v[198:199]
    v_pk_mul_f32 v[120:121], v[120:121], v[200:201]
    v_pk_mul_f32 v[122:123], v[122:123], v[202:203]
    v_pk_mul_f32 v[124:125], v[124:125], v[204:205]
    v_pk_mul_f32 v[126:127], v[126:127], v[206:207]
    v_cvt_pk_bf16_f32 v96, v112, v113
    v_cvt_pk_bf16_f32 v102, v124, v125
    v_cvt_pk_bf16_f32 v97, v114, v115
    v_cvt_pk_bf16_f32 v99, v118, v119
    v_cvt_pk_bf16_f32 v98, v116, v117
    v_cvt_pk_bf16_f32 v100, v120, v121
    v_cvt_pk_bf16_f32 v101, v122, v123
    v_cvt_pk_bf16_f32 v103, v126, v127
    global_store_dwordx4 v18, v[96:99], s[36:37] sc1
    global_store_dwordx4 v18, v[100:103], s[36:37] offset:1024 sc1
L_cons_pub:
    v_mov_b32 v27, 163660
    ds_read_b32 v27, v27
    v_lshrrev_b32 v3, 5, v0
    v_and_b32 v4, 15, v0
    v_lshrrev_b32 v4, 2, v4
    v_lshl_add_u32 v4, v3, 3, v4
    v_lshrrev_b32 v5, 4, v0
    v_and_b32 v5, 1, v5
    v_and_b32 v6, 3, v0
    v_lshrrev_b32 v8, 1, v6
    v_lshl_add_u32 v5, v5, 1, v8
    v_lshrrev_b32 v8, 1, v4
    v_and_b32 v8, 1, v8
    v_lshlrev_b32 v8, 2, v8
    v_xor_b32 v5, v5, v8
    v_lshlrev_b32 v4, 7, v4
    v_lshl_add_u32 v4, v5, 4, v4
    v_and_b32 v6, 1, v0
    v_lshl_add_u32 v4, v6, 3, v4
    s_mul_i32 s13, s8, 36864
    v_add_u32 v1, s13, v4
    v_xor_b32 v2, 64, v1
    s_mov_b32 s40, s36
    s_and_b32 s41, s37, 0xffff
    s_mov_b32 s42, 7733248
    s_mov_b32 s43, 0x20000
    s_lshl_b32 s13, s84, 1
    s_mul_i32 s13, s13, 120832
    v_lshlrev_b32 v3, 4, v0
    v_add_u32 v3, s13, v3
    v_add_u32 v4, 120832, v3
    v_mov_b32 v192, 0
    v_mov_b32 v193, 0
    v_mov_b32 v194, 0
    v_mov_b32 v195, 0
    s_nop 1
    v_mfma_f32_32x32x16_bf16 v[128:143], v[192:195], v[192:195], 0
    v_mfma_f32_32x32x16_bf16 v[144:159], v[192:195], v[192:195], 0
    v_mfma_f32_32x32x16_bf16 v[160:175], v[192:195], v[192:195], 0
    v_mfma_f32_32x32x16_bf16 v[176:191], v[192:195], v[192:195], 0
    v_and_b32 v5, 15, v0
    v_lshlrev_b32 v6, 1, v5
    v_add_u32 v5, 8, v5
    v_and_b32 v5, 15, v5
    v_lshlrev_b32 v5, 1, v5
    v_add_u32 v5, 1, v5
    v_and_b32 v24, 16, v0
    v_cmp_ne_u32 vcc, 0, v24
    s_nop 1
    v_cndmask_b32_e64 v5, v6, v5, vcc
    s_lshl_b32 s13, s84, 6
    s_lshr_b32 s14, s8, 1
    s_lshl_b32 s14, s14, 5
    s_add_u32 s13, s13, s14
    v_add_u32 v5, s13, v5
    v_lshlrev_b32 v5, 10, v5
    s_lshl_b32 s13, s85, 7
    s_and_b32 s14, s8, 1
    s_lshl_b32 s14, s14, 6
    s_add_u32 s13, s13, s14
    v_lshrrev_b32 v6, 5, v0
    v_lshlrev_b32 v25, 3, v6
    v_add_u32 v25, s13, v25
    v_add_u32 v24, v5, v25
    v_lshlrev_b32 v26, 4, v6
    v_add_u32 v26, s13, v26
    v_add_u32 v26, v5, v26
    s_waitcnt lgkmcnt(0)
    s_add_u32 s14, s76, 8
    s_cmp_eq_u32 s11, 0
    s_cselect_b32 s14, s10, s14
    s_lshl_b32 s13, s9, 4
    s_add_u32 s13, s13, s14
    s_lshl_b32 s13, s13, 2
    s_add_u32 s13, s13, s8
    s_lshl_b32 s13, s13, 7
    v_mov_b32 v28, s13
    s_waitcnt vmcnt(0)
    s_mov_b64 s[90:91], exec
    s_mov_b64 exec, 1
    global_store_dword v28, v27, s[64:65] sc1
    s_mov_b64 exec, s[90:91]
    s_barrier
    ds_read_b64_tr_b16 v[32:33], v1 offset:0
    ds_read_b64_tr_b16 v[34:35], v1 offset:512
    ds_read_b64_tr_b16 v[36:37], v2 offset:0
    ds_read_b64_tr_b16 v[38:39], v2 offset:512
    ds_read_b64_tr_b16 v[40:41], v1 offset:2048
    ds_read_b64_tr_b16 v[42:43], v1 offset:2560
    ds_read_b64_tr_b16 v[44:45], v2 offset:2048
    ds_read_b64_tr_b16 v[46:47], v2 offset:2560
    ds_read_b64_tr_b16 v[48:49], v1 offset:4096
    ds_read_b64_tr_b16 v[50:51], v1 offset:4608
    ds_read_b64_tr_b16 v[52:53], v2 offset:4096
    ds_read_b64_tr_b16 v[54:55], v2 offset:4608
    s_waitcnt lgkmcnt(8)
    ds_read_b64_tr_b16 v[56:57], v1 offset:6144
    ds_read_b64_tr_b16 v[58:59], v1 offset:6656
    ds_read_b64_tr_b16 v[60:61], v2 offset:6144
    ds_read_b64_tr_b16 v[62:63], v2 offset:6656
    s_waitcnt lgkmcnt(8)
    ds_read_b64_tr_b16 v[64:65], v1 offset:8192
    ds_read_b64_tr_b16 v[66:67], v1 offset:8704
    ds_read_b64_tr_b16 v[68:69], v2 offset:8192
    ds_read_b64_tr_b16 v[70:71], v2 offset:8704
    s_waitcnt lgkmcnt(8)
    ds_read_b64_tr_b16 v[72:73], v1 offset:10240
    ds_read_b64_tr_b16 v[74:75], v1 offset:10752
    ds_read_b64_tr_b16 v[76:77], v2 offset:10240
    ds_read_b64_tr_b16 v[78:79], v2 offset:10752
    s_waitcnt lgkmcnt(8)
    ds_read_b64_tr_b16 v[80:81], v1 offset:12288
    ds_read_b64_tr_b16 v[82:83], v1 offset:12800
    ds_read_b64_tr_b16 v[84:85], v2 offset:12288
    ds_read_b64_tr_b16 v[86:87], v2 offset:12800
    s_waitcnt lgkmcnt(8)
    ds_read_b64_tr_b16 v[88:89], v1 offset:14336
    ds_read_b64_tr_b16 v[90:91], v1 offset:14848
    ds_read_b64_tr_b16 v[92:93], v2 offset:14336
    ds_read_b64_tr_b16 v[94:95], v2 offset:14848
    s_waitcnt lgkmcnt(8)
    ds_read_b64_tr_b16 v[96:97], v1 offset:16384
    ds_read_b64_tr_b16 v[98:99], v1 offset:16896
    ds_read_b64_tr_b16 v[100:101], v2 offset:16384
    ds_read_b64_tr_b16 v[102:103], v2 offset:16896
    s_waitcnt lgkmcnt(8)
    ds_read_b64_tr_b16 v[104:105], v1 offset:18432
    ds_read_b64_tr_b16 v[106:107], v1 offset:18944
    ds_read_b64_tr_b16 v[108:109], v2 offset:18432
    ds_read_b64_tr_b16 v[110:111], v2 offset:18944
    s_waitcnt lgkmcnt(8)
    ds_read_b64_tr_b16 v[112:113], v1 offset:20480
    ds_read_b64_tr_b16 v[114:115], v1 offset:20992
    ds_read_b64_tr_b16 v[116:117], v2 offset:20480
    ds_read_b64_tr_b16 v[118:119], v2 offset:20992
    s_waitcnt lgkmcnt(8)
    ds_read_b64_tr_b16 v[120:121], v1 offset:22528
    ds_read_b64_tr_b16 v[122:123], v1 offset:23040
    ds_read_b64_tr_b16 v[124:125], v2 offset:22528
    ds_read_b64_tr_b16 v[126:127], v2 offset:23040
    s_waitcnt lgkmcnt(8)
    s_waitcnt lgkmcnt(0)
    s_barrier
    s_cmp_lg_u32 s8, 0
    s_cbranch_scc1 Ls2o_77
    v_min_u32 v28, 19, v0
    v_add_u32 v28, 44, v28
    s_lshl_b32 s13, s86, 6
    v_add_u32 v28, s13, v28
    v_lshlrev_b32 v28, 7, v28
    s_mov_b32 s95, 0
Ls2p_79:
    global_load_dword v29, v28, s[64:65] sc1
    s_waitcnt vmcnt(0)
    v_cmp_ne_u32 vcc, v27, v29
    s_nop 1
    s_cmp_eq_u64 vcc, 0
    s_cbranch_scc1 Ls2g_80
    s_add_u32 s95, s95, 1
    s_cmp_gt_u32 s95, 524288
    s_cbranch_scc1 Ls2g_80
    s_sleep 1
    s_branch Ls2p_79
Ls2g_80:
    v_mov_b32 v28, 163664
    v_mov_b32 v29, 1
    ds_write_b32 v28, v29
    s_waitcnt lgkmcnt(0)
    s_branch Ls2d_78
Ls2o_77:
    v_mov_b32 v28, 163664
    s_mov_b32 s95, 0
Ls2l_82:
    ds_read_b32 v29, v28
    s_waitcnt lgkmcnt(0)
    v_readfirstlane_b32 s94, v29
    s_nop 0
    s_cmp_eq_u32 s94, 1
    s_cbranch_scc1 Ls2e_83
    s_add_u32 s95, s95, 1
    s_cmp_gt_u32 s95, 8388608
    s_cbranch_scc1 Ls2e_83
    s_sleep 1
    s_branch Ls2l_82
Ls2e_83:
Ls2d_78:
Ls2pre_76:
    s_lshl_b32 s63, s8, 10
    s_add_u32 s63, s63, 69632
    buffer_load_dwordx4 v[208:211], v3, s[40:43], s63 offen sc1
    buffer_load_dwordx4 v[212:215], v4, s[40:43], s63 offen sc1
    s_add_u32 s63, s63, 4096
    buffer_load_dwordx4 v[216:219], v3, s[40:43], s63 offen sc1
    buffer_load_dwordx4 v[220:223], v4, s[40:43], s63 offen sc1
    s_add_u32 s63, s63, 4096
    buffer_load_dwordx4 v[224:227], v3, s[40:43], s63 offen sc1
    buffer_load_dwordx4 v[228:231], v4, s[40:43], s63 offen sc1
    s_add_u32 s63, s63, 4096
    buffer_load_dwordx4 v[232:235], v3, s[40:43], s63 offen sc1
    buffer_load_dwordx4 v[236:239], v4, s[40:43], s63 offen sc1
    s_add_u32 s63, s63, 4096
    buffer_load_dwordx4 v[240:243], v3, s[40:43], s63 offen sc1
    buffer_load_dwordx4 v[244:247], v4, s[40:43], s63 offen sc1
    s_add_u32 s63, s63, 4096
    buffer_load_dwordx4 v[248:251], v3, s[40:43], s63 offen sc1
    buffer_load_dwordx4 v[252:255], v4, s[40:43], s63 offen sc1
    s_waitcnt vmcnt(11)
    v_mfma_f32_32x32x16_bf16 v[128:143], v[32:35], v[208:211], v[128:143]
    s_add_u32 s63, s63, 4096
    v_mfma_f32_32x32x16_bf16 v[160:175], v[36:39], v[208:211], v[160:175]
    buffer_load_dwordx4 v[208:211], v3, s[40:43], s63 offen sc1
    s_waitcnt vmcnt(11)
    v_mfma_f32_32x32x16_bf16 v[144:159], v[32:35], v[212:215], v[144:159]
    v_mfma_f32_32x32x16_bf16 v[176:191], v[36:39], v[212:215], v[176:191]
    buffer_load_dwordx4 v[212:215], v4, s[40:43], s63 offen sc1
    s_waitcnt vmcnt(11)
    v_mfma_f32_32x32x16_bf16 v[128:143], v[40:43], v[216:219], v[128:143]
    s_add_u32 s63, s63, 4096
    v_mfma_f32_32x32x16_bf16 v[160:175], v[44:47], v[216:219], v[160:175]
    buffer_load_dwordx4 v[216:219], v3, s[40:43], s63 offen sc1
    s_waitcnt vmcnt(11)
    v_mfma_f32_32x32x16_bf16 v[144:159], v[40:43], v[220:223], v[144:159]
    v_mfma_f32_32x32x16_bf16 v[176:191], v[44:47], v[220:223], v[176:191]
    buffer_load_dwordx4 v[220:223], v4, s[40:43], s63 offen sc1
    s_waitcnt vmcnt(11)
    v_mfma_f32_32x32x16_bf16 v[128:143], v[48:51], v[224:227], v[128:143]
    s_add_u32 s63, s63, 4096
    v_mfma_f32_32x32x16_bf16 v[160:175], v[52:55], v[224:227], v[160:175]
    buffer_load_dwordx4 v[224:227], v3, s[40:43], s63 offen sc1
    s_waitcnt vmcnt(11)
    v_mfma_f32_32x32x16_bf16 v[144:159], v[48:51], v[228:231], v[144:159]
    v_mfma_f32_32x32x16_bf16 v[176:191], v[52:55], v[228:231], v[176:191]
    buffer_load_dwordx4 v[228:231], v4, s[40:43], s63 offen sc1
    s_waitcnt vmcnt(11)
    v_mfma_f32_32x32x16_bf16 v[128:143], v[56:59], v[232:235], v[128:143]
    s_add_u32 s63, s63, 4096
    v_mfma_f32_32x32x16_bf16 v[160:175], v[60:63], v[232:235], v[160:175]
    buffer_load_dwordx4 v[232:235], v3, s[40:43], s63 offen sc1
    s_waitcnt vmcnt(11)
    v_mfma_f32_32x32x16_bf16 v[144:159], v[56:59], v[236:239], v[144:159]
    v_mfma_f32_32x32x16_bf16 v[176:191], v[60:63], v[236:239], v[176:191]
    buffer_load_dwordx4 v[236:239], v4, s[40:43], s63 offen sc1
    s_waitcnt vmcnt(11)
    v_mfma_f32_32x32x16_bf16 v[128:143], v[64:67], v[240:243], v[128:143]
    s_add_u32 s63, s63, 4096
    v_mfma_f32_32x32x16_bf16 v[160:175], v[68:71], v[240:243], v[160:175]
    buffer_load_dwordx4 v[240:243], v3, s[40:43], s63 offen sc1
    s_waitcnt vmcnt(11)
    v_mfma_f32_32x32x16_bf16 v[144:159], v[64:67], v[244:247], v[144:159]
    v_mfma_f32_32x32x16_bf16 v[176:191], v[68:71], v[244:247], v[176:191]
    buffer_load_dwordx4 v[244:247], v4, s[40:43], s63 offen sc1
    v_min_u32 v28, 43, v0
    s_lshl_b32 s13, s86, 6
    v_add_u32 v28, s13, v28
    v_lshlrev_b32 v28, 7, v28
    s_cmp_eq_u32 s8, 0
    s_cselect_b64 s[90:91], -1, 1
    s_mov_b64 exec, s[90:91]
    global_load_dword v29, v28, s[64:65] sc1
    s_mov_b64 exec, -1
    s_waitcnt vmcnt(12)
    v_mfma_f32_32x32x16_bf16 v[128:143], v[72:75], v[248:251], v[128:143]
    s_add_u32 s63, s63, 4096
    v_mfma_f32_32x32x16_bf16 v[160:175], v[76:79], v[248:251], v[160:175]
    buffer_load_dwordx4 v[248:251], v3, s[40:43], s63 offen sc1
    s_waitcnt vmcnt(12)
    v_mfma_f32_32x32x16_bf16 v[144:159], v[72:75], v[252:255], v[144:159]
    v_mfma_f32_32x32x16_bf16 v[176:191], v[76:79], v[252:255], v[176:191]
    buffer_load_dwordx4 v[252:255], v4, s[40:43], s63 offen sc1
    s_waitcnt vmcnt(12)
    v_mfma_f32_32x32x16_bf16 v[128:143], v[80:83], v[208:211], v[128:143]
    s_cmp_lt_u32 s8, 2
    s_cselect_b32 s13, 4096, 0
    s_add_u32 s63, s63, s13
    v_mfma_f32_32x32x16_bf16 v[160:175], v[84:87], v[208:211], v[160:175]
    buffer_load_dwordx4 v[208:211], v3, s[40:43], s63 offen sc1
    s_waitcnt vmcnt(12)
    v_mfma_f32_32x32x16_bf16 v[144:159], v[80:83], v[212:215], v[144:159]
    v_mfma_f32_32x32x16_bf16 v[176:191], v[84:87], v[212:215], v[176:191]
    buffer_load_dwordx4 v[212:215], v4, s[40:43], s63 offen sc1
    s_waitcnt vmcnt(4)
    v_cmp_ne_u32 vcc, v27, v29
    s_nop 1
    s_cmp_lg_u32 s8, 0
    s_cbranch_scc1 Ls2bo_86
    s_cmp_eq_u64 vcc, 0
    s_cbranch_scc1 Ls2bok_84_set
    s_mov_b32 s95, 0
Ls2bp_85:
    global_load_dword v29, v28, s[64:65] sc1
    s_waitcnt vmcnt(0)
    v_cmp_ne_u32 vcc, v27, v29
    s_nop 1
    s_cmp_eq_u64 vcc, 0
    s_cbranch_scc1 Ls2bok_84_set
    s_add_u32 s95, s95, 1
    s_cmp_gt_u32 s95, 524288
    s_cbranch_scc1 Ls2bok_84_to
    s_sleep 1
    s_branch Ls2bp_85
Ls2bok_84_to:
Ls2bok_84_set:
    v_mov_b32 v28, 163668
    v_mov_b32 v30, 1
    ds_write_b32 v28, v30
    s_branch Ls2bok_84
Ls2bo_86:
    v_mov_b32 v28, 163668
    s_mov_b32 s95, 0
Ls2bl_87:
    ds_read_b32 v30, v28
    s_waitcnt lgkmcnt(0)
    v_readfirstlane_b32 s94, v30
    s_nop 0
    s_cmp_eq_u32 s94, 1
    s_cbranch_scc1 Ls2bok_84
    s_add_u32 s95, s95, 1
    s_cmp_gt_u32 s95, 8388608
    s_cbranch_scc1 Ls2bok_84
    s_branch Ls2bl_87
Ls2bok_84:
    s_waitcnt lgkmcnt(0)
    v_mfma_f32_32x32x16_bf16 v[128:143], v[88:91], v[216:219], v[128:143]
    s_lshl_b32 s63, s8, 10
    s_add_u32 s63, s63, 0
    v_mfma_f32_32x32x16_bf16 v[160:175], v[92:95], v[216:219], v[160:175]
    buffer_load_dwordx4 v[216:219], v3, s[40:43], s63 offen sc1
    v_mfma_f32_32x32x16_bf16 v[144:159], v[88:91], v[220:223], v[144:159]
    v_mfma_f32_32x32x16_bf16 v[176:191], v[92:95], v[220:223], v[176:191]
    buffer_load_dwordx4 v[220:223], v4, s[40:43], s63 offen sc1
    v_mfma_f32_32x32x16_bf16 v[128:143], v[96:99], v[224:227], v[128:143]
    s_add_u32 s63, s63, 4096
    v_mfma_f32_32x32x16_bf16 v[160:175], v[100:103], v[224:227], v[160:175]
    buffer_load_dwordx4 v[224:227], v3, s[40:43], s63 offen sc1
    v_mfma_f32_32x32x16_bf16 v[144:159], v[96:99], v[228:231], v[144:159]
    v_mfma_f32_32x32x16_bf16 v[176:191], v[100:103], v[228:231], v[176:191]
    buffer_load_dwordx4 v[228:231], v4, s[40:43], s63 offen sc1
    v_mfma_f32_32x32x16_bf16 v[128:143], v[104:107], v[232:235], v[128:143]
    s_add_u32 s63, s63, 4096
    v_mfma_f32_32x32x16_bf16 v[160:175], v[108:111], v[232:235], v[160:175]
    buffer_load_dwordx4 v[232:235], v3, s[40:43], s63 offen sc1
    v_mfma_f32_32x32x16_bf16 v[144:159], v[104:107], v[236:239], v[144:159]
    v_mfma_f32_32x32x16_bf16 v[176:191], v[108:111], v[236:239], v[176:191]
    buffer_load_dwordx4 v[236:239], v4, s[40:43], s63 offen sc1
    v_mfma_f32_32x32x16_bf16 v[128:143], v[112:115], v[240:243], v[128:143]
    ds_read_b64_tr_b16 v[192:193], v1 offset:24576
    ds_read_b64_tr_b16 v[194:195], v1 offset:25088
    s_add_u32 s63, s63, 4096
    v_mfma_f32_32x32x16_bf16 v[160:175], v[116:119], v[240:243], v[160:175]
    buffer_load_dwordx4 v[240:243], v3, s[40:43], s63 offen sc1
    v_mfma_f32_32x32x16_bf16 v[144:159], v[112:115], v[244:247], v[144:159]
    ds_read_b64_tr_b16 v[196:197], v2 offset:24576
    ds_read_b64_tr_b16 v[198:199], v2 offset:25088
    v_mfma_f32_32x32x16_bf16 v[176:191], v[116:119], v[244:247], v[176:191]
    buffer_load_dwordx4 v[244:247], v4, s[40:43], s63 offen sc1
    s_waitcnt vmcnt(11)
    v_mfma_f32_32x32x16_bf16 v[128:143], v[120:123], v[248:251], v[128:143]
    ds_read_b64_tr_b16 v[200:201], v1 offset:26624
    ds_read_b64_tr_b16 v[202:203], v1 offset:27136
    s_add_u32 s63, s63, 4096
    v_mfma_f32_32x32x16_bf16 v[160:175], v[124:127], v[248:251], v[160:175]
    buffer_load_dwordx4 v[248:251], v3, s[40:43], s63 offen sc1
    s_waitcnt vmcnt(11)
    v_mfma_f32_32x32x16_bf16 v[144:159], v[120:123], v[252:255], v[144:159]
    ds_read_b64_tr_b16 v[204:205], v2 offset:26624
    ds_read_b64_tr_b16 v[206:207], v2 offset:27136
    v_mfma_f32_32x32x16_bf16 v[176:191], v[124:127], v[252:255], v[176:191]
    buffer_load_dwordx4 v[252:255], v4, s[40:43], s63 offen sc1
    s_waitcnt lgkmcnt(6)
    s_waitcnt vmcnt(11)
    v_mfma_f32_32x32x16_bf16 v[128:143], v[192:195], v[208:211], v[128:143]
    ds_read_b64_tr_b16 v[8:9], v1 offset:28672
    ds_read_b64_tr_b16 v[10:11], v1 offset:29184
    s_add_u32 s63, s63, 4096
    s_waitcnt lgkmcnt(6)
    v_mfma_f32_32x32x16_bf16 v[160:175], v[196:199], v[208:211], v[160:175]
    buffer_load_dwordx4 v[208:211], v3, s[40:43], s63 offen sc1
    s_waitcnt vmcnt(11)
    v_mfma_f32_32x32x16_bf16 v[144:159], v[192:195], v[212:215], v[144:159]
    ds_read_b64_tr_b16 v[12:13], v2 offset:28672
    ds_read_b64_tr_b16 v[14:15], v2 offset:29184
    v_mfma_f32_32x32x16_bf16 v[176:191], v[196:199], v[212:215], v[176:191]
    buffer_load_dwordx4 v[212:215], v4, s[40:43], s63 offen sc1
    s_waitcnt lgkmcnt(6)
    s_waitcnt vmcnt(11)
    v_mfma_f32_32x32x16_bf16 v[128:143], v[200:203], v[216:219], v[128:143]
    ds_read_b64_tr_b16 v[192:193], v1 offset:30720
    ds_read_b64_tr_b16 v[194:195], v1 offset:31232
    s_add_u32 s63, s63, 4096
    s_waitcnt lgkmcnt(6)
    v_mfma_f32_32x32x16_bf16 v[160:175], v[204:207], v[216:219], v[160:175]
    buffer_load_dwordx4 v[216:219], v3, s[40:43], s63 offen sc1
    s_waitcnt vmcnt(11)
    v_mfma_f32_32x32x16_bf16 v[144:159], v[200:203], v[220:223], v[144:159]
    ds_read_b64_tr_b16 v[196:197], v2 offset:30720
    ds_read_b64_tr_b16 v[198:199], v2 offset:31232
    v_mfma_f32_32x32x16_bf16 v[176:191], v[204:207], v[220:223], v[176:191]
    buffer_load_dwordx4 v[220:223], v4, s[40:43], s63 offen sc1
    s_waitcnt lgkmcnt(6)
    s_waitcnt vmcnt(11)
    v_mfma_f32_32x32x16_bf16 v[128:143], v[8:11], v[224:227], v[128:143]
    ds_read_b64_tr_b16 v[200:201], v1 offset:32768
    ds_read_b64_tr_b16 v[202:203], v1 offset:33280
    s_add_u32 s63, s63, 4096
    s_waitcnt lgkmcnt(6)
    v_mfma_f32_32x32x16_bf16 v[160:175], v[12:15], v[224:227], v[160:175]
    buffer_load_dwordx4 v[224:227], v3, s[40:43], s63 offen sc1
    s_waitcnt vmcnt(11)
    v_mfma_f32_32x32x16_bf16 v[144:159], v[8:11], v[228:231], v[144:159]
    ds_read_b64_tr_b16 v[204:205], v2 offset:32768
    ds_read_b64_tr_b16 v[206:207], v2 offset:33280
    v_mfma_f32_32x32x16_bf16 v[176:191], v[12:15], v[228:231], v[176:191]
    buffer_load_dwordx4 v[228:231], v4, s[40:43], s63 offen sc1
    s_waitcnt lgkmcnt(6)
    s_waitcnt vmcnt(11)
    v_mfma_f32_32x32x16_bf16 v[128:143], v[192:195], v[232:235], v[128:143]
    ds_read_b64_tr_b16 v[8:9], v1 offset:34816
    ds_read_b64_tr_b16 v[10:11], v1 offset:35328
    s_add_u32 s63, s63, 4096
    s_waitcnt lgkmcnt(6)
    v_mfma_f32_32x32x16_bf16 v[160:175], v[196:199], v[232:235], v[160:175]
    buffer_load_dwordx4 v[232:235], v3, s[40:43], s63 offen sc1
    s_waitcnt vmcnt(11)
    v_mfma_f32_32x32x16_bf16 v[144:159], v[192:195], v[236:239], v[144:159]
    ds_read_b64_tr_b16 v[12:13], v2 offset:34816
    ds_read_b64_tr_b16 v[14:15], v2 offset:35328
    v_mfma_f32_32x32x16_bf16 v[176:191], v[196:199], v[236:239], v[176:191]
    buffer_load_dwordx4 v[236:239], v4, s[40:43], s63 offen sc1
    s_barrier
    s_waitcnt lgkmcnt(6)
    s_waitcnt vmcnt(11)
    v_mfma_f32_32x32x16_bf16 v[128:143], v[200:203], v[240:243], v[128:143]
    ds_read_b64_tr_b16 v[192:193], v1 offset:0
    ds_read_b64_tr_b16 v[194:195], v1 offset:512
    s_add_u32 s63, s63, 4096
    s_waitcnt lgkmcnt(6)
    v_mfma_f32_32x32x16_bf16 v[160:175], v[204:207], v[240:243], v[160:175]
    buffer_load_dwordx4 v[240:243], v3, s[40:43], s63 offen sc1
    s_waitcnt vmcnt(11)
    v_mfma_f32_32x32x16_bf16 v[144:159], v[200:203], v[244:247], v[144:159]
    ds_read_b64_tr_b16 v[196:197], v2 offset:0
    ds_read_b64_tr_b16 v[198:199], v2 offset:512
    v_mfma_f32_32x32x16_bf16 v[176:191], v[204:207], v[244:247], v[176:191]
    buffer_load_dwordx4 v[244:247], v4, s[40:43], s63 offen sc1
    s_waitcnt lgkmcnt(6)
    s_waitcnt vmcnt(11)
    v_mfma_f32_32x32x16_bf16 v[128:143], v[8:11], v[248:251], v[128:143]
    ds_read_b64_tr_b16 v[200:201], v1 offset:2048
    ds_read_b64_tr_b16 v[202:203], v1 offset:2560
    s_add_u32 s63, s63, 4096
    s_waitcnt lgkmcnt(6)
    v_mfma_f32_32x32x16_bf16 v[160:175], v[12:15], v[248:251], v[160:175]
    buffer_load_dwordx4 v[248:251], v3, s[40:43], s63 offen sc1
    s_waitcnt vmcnt(11)
    v_mfma_f32_32x32x16_bf16 v[144:159], v[8:11], v[252:255], v[144:159]
    ds_read_b64_tr_b16 v[204:205], v2 offset:2048
    ds_read_b64_tr_b16 v[206:207], v2 offset:2560
    v_mfma_f32_32x32x16_bf16 v[176:191], v[12:15], v[252:255], v[176:191]
    buffer_load_dwordx4 v[252:255], v4, s[40:43], s63 offen sc1
    s_waitcnt lgkmcnt(6)
    s_waitcnt vmcnt(11)
    v_mfma_f32_32x32x16_bf16 v[128:143], v[192:195], v[208:211], v[128:143]
    ds_read_b64_tr_b16 v[8:9], v1 offset:4096
    ds_read_b64_tr_b16 v[10:11], v1 offset:4608
    s_add_u32 s63, s63, 4096
    s_waitcnt lgkmcnt(6)
    v_mfma_f32_32x32x16_bf16 v[160:175], v[196:199], v[208:211], v[160:175]
    buffer_load_dwordx4 v[208:211], v3, s[40:43], s63 offen sc1
    s_waitcnt vmcnt(11)
    v_mfma_f32_32x32x16_bf16 v[144:159], v[192:195], v[212:215], v[144:159]
    ds_read_b64_tr_b16 v[12:13], v2 offset:4096
    ds_read_b64_tr_b16 v[14:15], v2 offset:4608
    v_mfma_f32_32x32x16_bf16 v[176:191], v[196:199], v[212:215], v[176:191]
    buffer_load_dwordx4 v[212:215], v4, s[40:43], s63 offen sc1
    s_waitcnt lgkmcnt(6)
    s_waitcnt vmcnt(11)
    v_mfma_f32_32x32x16_bf16 v[128:143], v[200:203], v[216:219], v[128:143]
    ds_read_b64_tr_b16 v[192:193], v1 offset:6144
    ds_read_b64_tr_b16 v[194:195], v1 offset:6656
    s_add_u32 s63, s63, 4096
    s_waitcnt lgkmcnt(6)
    v_mfma_f32_32x32x16_bf16 v[160:175], v[204:207], v[216:219], v[160:175]
    buffer_load_dwordx4 v[216:219], v3, s[40:43], s63 offen sc1
    s_waitcnt vmcnt(11)
    v_mfma_f32_32x32x16_bf16 v[144:159], v[200:203], v[220:223], v[144:159]
    ds_read_b64_tr_b16 v[196:197], v2 offset:6144
    ds_read_b64_tr_b16 v[198:199], v2 offset:6656
    v_mfma_f32_32x32x16_bf16 v[176:191], v[204:207], v[220:223], v[176:191]
    buffer_load_dwordx4 v[220:223], v4, s[40:43], s63 offen sc1
    s_waitcnt lgkmcnt(6)
    s_waitcnt vmcnt(11)
    v_mfma_f32_32x32x16_bf16 v[128:143], v[8:11], v[224:227], v[128:143]
    ds_read_b64_tr_b16 v[200:201], v1 offset:8192
    ds_read_b64_tr_b16 v[202:203], v1 offset:8704
    s_add_u32 s63, s63, 4096
    s_waitcnt lgkmcnt(6)
    v_mfma_f32_32x32x16_bf16 v[160:175], v[12:15], v[224:227], v[160:175]
    buffer_load_dwordx4 v[224:227], v3, s[40:43], s63 offen sc1
    s_waitcnt vmcnt(11)
    v_mfma_f32_32x32x16_bf16 v[144:159], v[8:11], v[228:231], v[144:159]
    ds_read_b64_tr_b16 v[204:205], v2 offset:8192
    ds_read_b64_tr_b16 v[206:207], v2 offset:8704
    v_mfma_f32_32x32x16_bf16 v[176:191], v[12:15], v[228:231], v[176:191]
    buffer_load_dwordx4 v[228:231], v4, s[40:43], s63 offen sc1
    s_waitcnt lgkmcnt(6)
    s_waitcnt vmcnt(11)
    v_mfma_f32_32x32x16_bf16 v[128:143], v[192:195], v[232:235], v[128:143]
    ds_read_b64_tr_b16 v[8:9], v1 offset:10240
    ds_read_b64_tr_b16 v[10:11], v1 offset:10752
    s_add_u32 s63, s63, 4096
    s_waitcnt lgkmcnt(6)
    v_mfma_f32_32x32x16_bf16 v[160:175], v[196:199], v[232:235], v[160:175]
    buffer_load_dwordx4 v[232:235], v3, s[40:43], s63 offen sc1
    s_waitcnt vmcnt(11)
    v_mfma_f32_32x32x16_bf16 v[144:159], v[192:195], v[236:239], v[144:159]
    ds_read_b64_tr_b16 v[12:13], v2 offset:10240
    ds_read_b64_tr_b16 v[14:15], v2 offset:10752
    v_mfma_f32_32x32x16_bf16 v[176:191], v[196:199], v[236:239], v[176:191]
    buffer_load_dwordx4 v[236:239], v4, s[40:43], s63 offen sc1
    s_waitcnt lgkmcnt(6)
    s_waitcnt vmcnt(11)
    v_mfma_f32_32x32x16_bf16 v[128:143], v[200:203], v[240:243], v[128:143]
    ds_read_b64_tr_b16 v[192:193], v1 offset:12288
    ds_read_b64_tr_b16 v[194:195], v1 offset:12800
    s_add_u32 s63, s63, 4096
    s_waitcnt lgkmcnt(6)
    v_mfma_f32_32x32x16_bf16 v[160:175], v[204:207], v[240:243], v[160:175]
    buffer_load_dwordx4 v[240:243], v3, s[40:43], s63 offen sc1
    s_waitcnt vmcnt(11)
    v_mfma_f32_32x32x16_bf16 v[144:159], v[200:203], v[244:247], v[144:159]
    ds_read_b64_tr_b16 v[196:197], v2 offset:12288
    ds_read_b64_tr_b16 v[198:199], v2 offset:12800
    v_mfma_f32_32x32x16_bf16 v[176:191], v[204:207], v[244:247], v[176:191]
    buffer_load_dwordx4 v[244:247], v4, s[40:43], s63 offen sc1
    s_waitcnt lgkmcnt(6)
    s_waitcnt vmcnt(11)
    v_mfma_f32_32x32x16_bf16 v[128:143], v[8:11], v[248:251], v[128:143]
    ds_read_b64_tr_b16 v[200:201], v1 offset:14336
    ds_read_b64_tr_b16 v[202:203], v1 offset:14848
    s_add_u32 s63, s63, 4096
    s_waitcnt lgkmcnt(6)
    v_mfma_f32_32x32x16_bf16 v[160:175], v[12:15], v[248:251], v[160:175]
    buffer_load_dwordx4 v[248:251], v3, s[40:43], s63 offen sc1
    s_waitcnt vmcnt(11)
    v_mfma_f32_32x32x16_bf16 v[144:159], v[8:11], v[252:255], v[144:159]
    ds_read_b64_tr_b16 v[204:205], v2 offset:14336
    ds_read_b64_tr_b16 v[206:207], v2 offset:14848
    v_mfma_f32_32x32x16_bf16 v[176:191], v[12:15], v[252:255], v[176:191]
    buffer_load_dwordx4 v[252:255], v4, s[40:43], s63 offen sc1
    s_waitcnt lgkmcnt(6)
    s_waitcnt vmcnt(11)
    v_mfma_f32_32x32x16_bf16 v[128:143], v[192:195], v[208:211], v[128:143]
    ds_read_b64_tr_b16 v[8:9], v1 offset:16384
    ds_read_b64_tr_b16 v[10:11], v1 offset:16896
    s_waitcnt lgkmcnt(6)
    v_mfma_f32_32x32x16_bf16 v[160:175], v[196:199], v[208:211], v[160:175]
    s_waitcnt vmcnt(10)
    v_mfma_f32_32x32x16_bf16 v[144:159], v[192:195], v[212:215], v[144:159]
    ds_read_b64_tr_b16 v[12:13], v2 offset:16384
    ds_read_b64_tr_b16 v[14:15], v2 offset:16896
    v_mfma_f32_32x32x16_bf16 v[176:191], v[196:199], v[212:215], v[176:191]
    global_load_dwordx2 v[96:97], v24, s[16:17] offset:0
    global_load_dwordx2 v[104:105], v25, s[30:31] offset:0
    global_load_dwordx2 v[98:99], v24, s[16:17] offset:16
    global_load_dwordx2 v[106:107], v25, s[30:31] offset:16
    global_load_dwordx2 v[100:101], v24, s[16:17] offset:32
    global_load_dwordx2 v[108:109], v25, s[30:31] offset:32
    global_load_dwordx2 v[102:103], v24, s[16:17] offset:48
    global_load_dwordx2 v[110:111], v25, s[30:31] offset:48
    s_waitcnt lgkmcnt(6)
    s_waitcnt vmcnt(17)
    v_mfma_f32_32x32x16_bf16 v[128:143], v[200:203], v[216:219], v[128:143]
    ds_read_b64_tr_b16 v[192:193], v1 offset:18432
    ds_read_b64_tr_b16 v[194:195], v1 offset:18944
    s_waitcnt lgkmcnt(6)
    v_mfma_f32_32x32x16_bf16 v[160:175], v[204:207], v[216:219], v[160:175]
    s_waitcnt vmcnt(16)
    v_mfma_f32_32x32x16_bf16 v[144:159], v[200:203], v[220:223], v[144:159]
    ds_read_b64_tr_b16 v[196:197], v2 offset:18432
    ds_read_b64_tr_b16 v[198:199], v2 offset:18944
    v_mfma_f32_32x32x16_bf16 v[176:191], v[204:207], v[220:223], v[176:191]
    s_waitcnt lgkmcnt(6)
    s_waitcnt vmcnt(15)
    v_mfma_f32_32x32x16_bf16 v[128:143], v[8:11], v[224:227], v[128:143]
    ds_read_b64_tr_b16 v[200:201], v1 offset:20480
    ds_read_b64_tr_b16 v[202:203], v1 offset:20992
    s_waitcnt lgkmcnt(6)
    v_mfma_f32_32x32x16_bf16 v[160:175], v[12:15], v[224:227], v[160:175]
    s_waitcnt vmcnt(14)
    v_mfma_f32_32x32x16_bf16 v[144:159], v[8:11], v[228:231], v[144:159]
    ds_read_b64_tr_b16 v[204:205], v2 offset:20480
    ds_read_b64_tr_b16 v[206:207], v2 offset:20992
    v_mfma_f32_32x32x16_bf16 v[176:191], v[12:15], v[228:231], v[176:191]
    s_waitcnt lgkmcnt(6)
    s_waitcnt vmcnt(13)
    v_mfma_f32_32x32x16_bf16 v[128:143], v[192:195], v[232:235], v[128:143]
    ds_read_b64_tr_b16 v[8:9], v1 offset:22528
    ds_read_b64_tr_b16 v[10:11], v1 offset:23040
    s_waitcnt lgkmcnt(6)
    v_mfma_f32_32x32x16_bf16 v[160:175], v[196:199], v[232:235], v[160:175]
    s_waitcnt vmcnt(12)
    v_mfma_f32_32x32x16_bf16 v[144:159], v[192:195], v[236:239], v[144:159]
    ds_read_b64_tr_b16 v[12:13], v2 offset:22528
    ds_read_b64_tr_b16 v[14:15], v2 offset:23040
    v_mfma_f32_32x32x16_bf16 v[176:191], v[196:199], v[236:239], v[176:191]
    s_waitcnt lgkmcnt(6)
    s_waitcnt vmcnt(11)
    v_mfma_f32_32x32x16_bf16 v[128:143], v[200:203], v[240:243], v[128:143]
    s_waitcnt lgkmcnt(4)
    v_mfma_f32_32x32x16_bf16 v[160:175], v[204:207], v[240:243], v[160:175]
    s_waitcnt vmcnt(10)
    v_mfma_f32_32x32x16_bf16 v[144:159], v[200:203], v[244:247], v[144:159]
    v_mfma_f32_32x32x16_bf16 v[176:191], v[204:207], v[244:247], v[176:191]
    s_waitcnt lgkmcnt(2)
    s_waitcnt vmcnt(9)
    v_mfma_f32_32x32x16_bf16 v[128:143], v[8:11], v[248:251], v[128:143]
    s_waitcnt lgkmcnt(0)
    v_mfma_f32_32x32x16_bf16 v[160:175], v[12:15], v[248:251], v[160:175]
    s_waitcnt vmcnt(8)
    v_mfma_f32_32x32x16_bf16 v[144:159], v[8:11], v[252:255], v[144:159]
    v_mfma_f32_32x32x16_bf16 v[176:191], v[12:15], v[252:255], v[176:191]
L_p2_red:
    s_nop 11
    s_mul_i32 s14, s8, 36864
    v_lshlrev_b32 v3, 4, v0
    v_add_u32 v5, s14, v3
    s_cmp_eq_u32 s8, 0
    s_cbranch_scc1 Lrown_88
    s_sub_u32 s13, 3, s8
    s_and_b32 s13, s13, 3
    s_lshl_b32 s13, s13, 12
    v_add_u32 v4, s13, v5
    ds_write_b128 v4, v[128:131] offset:0
    ds_write_b128 v4, v[132:135] offset:1024
    ds_write_b128 v4, v[136:139] offset:2048
    ds_write_b128 v4, v[140:143] offset:3072
    s_branch Lrdn_89
Lrown_88:
    v_mov_b64 v[32:33], v[128:129]
    v_mov_b64 v[34:35], v[130:131]
    v_mov_b64 v[36:37], v[132:133]
    v_mov_b64 v[38:39], v[134:135]
    v_mov_b64 v[40:41], v[136:137]
    v_mov_b64 v[42:43], v[138:139]
    v_mov_b64 v[44:45], v[140:141]
    v_mov_b64 v[46:47], v[142:143]
Lrdn_89:
    s_cmp_eq_u32 s8, 1
    s_cbranch_scc1 Lrown_90
    s_sub_u32 s13, 4, s8
    s_and_b32 s13, s13, 3
    s_lshl_b32 s13, s13, 12
    v_add_u32 v4, s13, v5
    ds_write_b128 v4, v[160:163] offset:0
    ds_write_b128 v4, v[164:167] offset:1024
    ds_write_b128 v4, v[168:171] offset:2048
    ds_write_b128 v4, v[172:175] offset:3072
    s_branch Lrdn_91
Lrown_90:
    v_mov_b64 v[32:33], v[160:161]
    v_mov_b64 v[34:35], v[162:163]
    v_mov_b64 v[36:37], v[164:165]
    v_mov_b64 v[38:39], v[166:167]
    v_mov_b64 v[40:41], v[168:169]
    v_mov_b64 v[42:43], v[170:171]
    v_mov_b64 v[44:45], v[172:173]
    v_mov_b64 v[46:47], v[174:175]
Lrdn_91:
    s_cmp_eq_u32 s8, 2
    s_cbranch_scc1 Lrown_92
    s_sub_u32 s13, 5, s8
    s_and_b32 s13, s13, 3
    s_lshl_b32 s13, s13, 12
    v_add_u32 v4, s13, v5
    ds_write_b128 v4, v[144:147] offset:0
    ds_write_b128 v4, v[148:151] offset:1024
    ds_write_b128 v4, v[152:155] offset:2048
    ds_write_b128 v4, v[156:159] offset:3072
    s_branch Lrdn_93
Lrown_92:
    v_mov_b64 v[32:33], v[144:145]
    v_mov_b64 v[34:35], v[146:147]
    v_mov_b64 v[36:37], v[148:149]
    v_mov_b64 v[38:39], v[150:151]
    v_mov_b64 v[40:41], v[152:153]
    v_mov_b64 v[42:43], v[154:155]
    v_mov_b64 v[44:45], v[156:157]
    v_mov_b64 v[46:47], v[158:159]
Lrdn_93:
    s_cmp_eq_u32 s8, 3
    s_cbranch_scc1 Lrown_94
    s_sub_u32 s13, 6, s8
    s_and_b32 s13, s13, 3
    s_lshl_b32 s13, s13, 12
    v_add_u32 v4, s13, v5
    ds_write_b128 v4, v[176:179] offset:0
    ds_write_b128 v4, v[180:183] offset:1024
    ds_write_b128 v4, v[184:187] offset:2048
    ds_write_b128 v4, v[188:191] offset:3072
    s_branch Lrdn_95
Lrown_94:
    v_mov_b64 v[32:33], v[176:177]
    v_mov_b64 v[34:35], v[178:179]
    v_mov_b64 v[36:37], v[180:181]
    v_mov_b64 v[38:39], v[182:183]
    v_mov_b64 v[40:41], v[184:185]
    v_mov_b64 v[42:43], v[186:187]
    v_mov_b64 v[44:45], v[188:189]
    v_mov_b64 v[46:47], v[190:191]
Lrdn_95:
    s_waitcnt lgkmcnt(0)
    s_barrier
    s_add_u32 s13, s8, 3
    s_and_b32 s13, s13, 3
    s_mul_i32 s13, s13, 36864
    v_add_u32 v4, s13, v3
    ds_read_b128 v[48:51], v4 offset:0
    ds_read_b128 v[52:55], v4 offset:1024
    ds_read_b128 v[56:59], v4 offset:2048
    ds_read_b128 v[60:63], v4 offset:3072
    s_add_u32 s13, s8, 2
    s_and_b32 s13, s13, 3
    s_mul_i32 s13, s13, 36864
    v_add_u32 v4, s13, v3
    ds_read_b128 v[64:67], v4 offset:4096
    ds_read_b128 v[68:71], v4 offset:5120
    ds_read_b128 v[72:75], v4 offset:6144
    ds_read_b128 v[76:79], v4 offset:7168
    s_add_u32 s13, s8, 1
    s_and_b32 s13, s13, 3
    s_mul_i32 s13, s13, 36864
    v_add_u32 v4, s13, v3
    ds_read_b128 v[80:83], v4 offset:8192
    ds_read_b128 v[84:87], v4 offset:9216
    ds_read_b128 v[88:91], v4 offset:10240
    ds_read_b128 v[92:95], v4 offset:11264
    s_waitcnt vmcnt(7)
    v_lshlrev_b32 v112, 16, v96
    v_and_b32 v113, 0xffff0000, v96
    v_pk_add_f32 v[32:33], v[32:33], v[112:113]
    v_lshlrev_b32 v112, 16, v97
    v_and_b32 v113, 0xffff0000, v97
    v_pk_add_f32 v[34:35], v[34:35], v[112:113]
    s_waitcnt vmcnt(5)
    v_lshlrev_b32 v112, 16, v98
    v_and_b32 v113, 0xffff0000, v98
    v_pk_add_f32 v[36:37], v[36:37], v[112:113]
    v_lshlrev_b32 v112, 16, v99
    v_and_b32 v113, 0xffff0000, v99
    v_pk_add_f32 v[38:39], v[38:39], v[112:113]
    s_waitcnt vmcnt(3)
    v_lshlrev_b32 v112, 16, v100
    v_and_b32 v113, 0xffff0000, v100
    v_pk_add_f32 v[40:41], v[40:41], v[112:113]
    v_lshlrev_b32 v112, 16, v101
    v_and_b32 v113, 0xffff0000, v101
    v_pk_add_f32 v[42:43], v[42:43], v[112:113]
    s_waitcnt vmcnt(1)
    v_lshlrev_b32 v112, 16, v102
    v_and_b32 v113, 0xffff0000, v102
    v_pk_add_f32 v[44:45], v[44:45], v[112:113]
    v_lshlrev_b32 v112, 16, v103
    v_and_b32 v113, 0xffff0000, v103
    v_pk_add_f32 v[46:47], v[46:47], v[112:113]
    v_lshlrev_b32 v112, 16, v104
    v_and_b32 v113, 0xffff0000, v104
    v_pk_add_f32 v[32:33], v[32:33], v[112:113]
    v_lshlrev_b32 v112, 16, v105
    v_and_b32 v113, 0xffff0000, v105
    v_pk_add_f32 v[34:35], v[34:35], v[112:113]
    v_lshlrev_b32 v112, 16, v106
    v_and_b32 v113, 0xffff0000, v106
    v_pk_add_f32 v[36:37], v[36:37], v[112:113]
    v_lshlrev_b32 v112, 16, v107
    v_and_b32 v113, 0xffff0000, v107
    v_pk_add_f32 v[38:39], v[38:39], v[112:113]
    v_lshlrev_b32 v112, 16, v108
    v_and_b32 v113, 0xffff0000, v108
    v_pk_add_f32 v[40:41], v[40:41], v[112:113]
    v_lshlrev_b32 v112, 16, v109
    v_and_b32 v113, 0xffff0000, v109
    v_pk_add_f32 v[42:43], v[42:43], v[112:113]
    s_waitcnt vmcnt(0)
    v_lshlrev_b32 v112, 16, v110
    v_and_b32 v113, 0xffff0000, v110
    v_pk_add_f32 v[44:45], v[44:45], v[112:113]
    v_lshlrev_b32 v112, 16, v111
    v_and_b32 v113, 0xffff0000, v111
    v_pk_add_f32 v[46:47], v[46:47], v[112:113]
    s_waitcnt lgkmcnt(11)
    v_pk_add_f32 v[32:33], v[32:33], v[48:49]
    v_pk_add_f32 v[34:35], v[34:35], v[50:51]
    s_waitcnt lgkmcnt(10)
    v_pk_add_f32 v[36:37], v[36:37], v[52:53]
    v_pk_add_f32 v[38:39], v[38:39], v[54:55]
    s_waitcnt lgkmcnt(9)
    v_pk_add_f32 v[40:41], v[40:41], v[56:57]
    v_pk_add_f32 v[42:43], v[42:43], v[58:59]
    s_waitcnt lgkmcnt(8)
    v_pk_add_f32 v[44:45], v[44:45], v[60:61]
    v_pk_add_f32 v[46:47], v[46:47], v[62:63]
    s_waitcnt lgkmcnt(7)
    v_pk_add_f32 v[32:33], v[32:33], v[64:65]
    v_pk_add_f32 v[34:35], v[34:35], v[66:67]
    s_waitcnt lgkmcnt(6)
    v_pk_add_f32 v[36:37], v[36:37], v[68:69]
    v_pk_add_f32 v[38:39], v[38:39], v[70:71]
    s_waitcnt lgkmcnt(5)
    v_pk_add_f32 v[40:41], v[40:41], v[72:73]
    v_pk_add_f32 v[42:43], v[42:43], v[74:75]
    s_waitcnt lgkmcnt(4)
    v_pk_add_f32 v[44:45], v[44:45], v[76:77]
    v_pk_add_f32 v[46:47], v[46:47], v[78:79]
    s_waitcnt lgkmcnt(3)
    v_pk_add_f32 v[32:33], v[32:33], v[80:81]
    v_pk_add_f32 v[34:35], v[34:35], v[82:83]
    s_waitcnt lgkmcnt(2)
    v_pk_add_f32 v[36:37], v[36:37], v[84:85]
    v_pk_add_f32 v[38:39], v[38:39], v[86:87]
    s_waitcnt lgkmcnt(1)
    v_pk_add_f32 v[40:41], v[40:41], v[88:89]
    v_pk_add_f32 v[42:43], v[42:43], v[90:91]
    s_waitcnt lgkmcnt(0)
    v_pk_add_f32 v[44:45], v[44:45], v[92:93]
    v_pk_add_f32 v[46:47], v[46:47], v[94:95]
    v_cvt_pk_bf16_f32 v116, v32, v33
    v_cvt_pk_bf16_f32 v117, v34, v35
    v_cvt_pk_bf16_f32 v118, v36, v37
    v_cvt_pk_bf16_f32 v119, v38, v39
    v_cvt_pk_bf16_f32 v120, v40, v41
    v_cvt_pk_bf16_f32 v121, v42, v43
    v_cvt_pk_bf16_f32 v122, v44, v45
    v_cvt_pk_bf16_f32 v123, v46, v47
    v_permlane32_swap_b32 v116, v118
    v_permlane32_swap_b32 v117, v119
    v_permlane32_swap_b32 v120, v122
    v_permlane32_swap_b32 v121, v123
    global_store_dwordx4 v26, v[116:119], s[32:33] offset:0 nt
    global_store_dwordx4 v26, v[120:123], s[32:33] offset:32 nt
L_exit:
    s_endpgm
L_s1step:
    v_mov_b32 v72, 163660
    ds_read_b32 v72, v72
    v_mov_b32 v73, 0
    s_waitcnt lgkmcnt(0)
    v_xor_b32 v74, v72, v33
    v_xor_b32 v75, v72, v35
    v_or3_b32 v73, v73, v74, v75
    v_xor_b32 v74, v72, v37
    v_xor_b32 v75, v72, v39
    v_or3_b32 v73, v73, v74, v75
    v_xor_b32 v74, v72, v41
    v_xor_b32 v75, v72, v43
    v_or3_b32 v73, v73, v74, v75
    v_xor_b32 v74, v72, v45
    v_xor_b32 v75, v72, v47
    v_or3_b32 v73, v73, v74, v75
    v_xor_b32 v74, v72, v49
    v_xor_b32 v75, v72, v51
    v_or3_b32 v73, v73, v74, v75
    v_xor_b32 v74, v72, v53
    v_xor_b32 v75, v72, v55
    v_or3_b32 v73, v73, v74, v75
    v_cmp_ne_u32 vcc, 0, v73
    s_nop 1
    s_cmp_eq_u64 vcc, 0
    s_cbranch_scc0 Ls1bad_96
    v_add_f32 v32, v32, v36
    v_add_f32 v40, v40, v44
    v_add_f32 v32, v32, v40
    v_add_f32 v34, v34, v38
    v_add_f32 v42, v42, v46
    v_add_f32 v34, v34, v42
    v_mul_f32 v32, 0x3b000000, v32
    v_mul_f32 v33, 0x3b000000, v34
    v_fma_f32 v33, -v32, v32, v33
    v_max_f32 v33, 0, v33
    v_add_f32 v34, 0x3727c5ac, v33
    v_rsq_f32 v34, v34
    s_nop 0
    v_mul_f32 v35, v33, v34
    v_mul_f32 v35, v35, v34
    v_add_f32 v35, 0x3727c5ac, v35
    v_rsq_f32 v35, v35
    s_nop 0
    v_mul_f32 v35, v35, v34
    s_cmp_eq_u32 s11, 0
    s_cselect_b64 s[90:91], -1, 0
    v_cndmask_b32_e64 v36, v35, v34, s[90:91]
    v_mul_f32 v37, v36, v32
    v_add_f32 v48, v48, v50
    v_add_f32 v48, v48, v52
    v_add_f32 v48, v48, v54
    v_lshlrev_b32 v64, 16, v64
    s_sub_u32 s14, s8, 4
    s_lshl_b32 s14, s14, 6
    v_add_u32 v76, s14, v0
    v_lshlrev_b32 v77, 2, v76
    v_lshlrev_b32 v76, 3, v76
    v_add_u32 v76, 155648, v76
    v_add_u32 v77, 156800, v77
    ds_write_b32 v77, v48 offset:1152
    ds_write_b32 v77, v64 offset:1920
    s_cmp_eq_u32 s8, 6
    s_cselect_b64 s[90:91], 0xffff, -1
    s_mov_b64 exec, s[90:91]
    ds_write_b64 v76, v[36:37]
    ds_write_b32 v77, v36
    ds_write_b32 v77, v37 offset:576
    s_mov_b64 exec, -1
    s_waitcnt lgkmcnt(0)
    s_lshl_b32 s14, s8, 2
    s_add_u32 s14, s14, 163632
    v_mov_b32 v76, s14
    v_mov_b32 v77, 1
    ds_write_b32 v76, v77
    s_waitcnt lgkmcnt(0)
    s_mov_b32 s63, 1
    s_setpc_b64 s[98:99]
Ls1bad_96:
    global_load_dwordx4 v[32:35], v66, s[36:37] sc1
    v_add_u32 v66, 32768, v66
    global_load_dwordx4 v[36:39], v66, s[36:37] sc1
    v_add_u32 v66, 32768, v66
    global_load_dwordx4 v[40:43], v66, s[36:37] sc1
    v_add_u32 v66, 32768, v66
    global_load_dwordx4 v[44:47], v66, s[36:37] sc1
    v_subrev_u32 v66, 98304, v66
    global_load_dwordx2 v[48:49], v67, s[36:37] sc1
    v_add_u32 v67, 23552, v67
    global_load_dwordx2 v[50:51], v67, s[36:37] sc1
    v_add_u32 v67, 23552, v67
    global_load_dwordx2 v[52:53], v67, s[36:37] sc1
    v_add_u32 v67, 23552, v67
    global_load_dwordx2 v[54:55], v67, s[36:37] sc1
    v_subrev_u32 v67, 70656, v67
    global_load_ushort v64, v68, s[26:27]
    s_setpc_b64 s[98:99]
L_hop_ret:
    s_setpc_b64 s[98:99]
L_code_end:
    s_nop 0
.section .rodata,"a"
.p2align 6
.amdhsa_kernel parallel_sum__sliding_local_dilated__mixer_channel_mlp__prompt_kernel
  .amdhsa_next_free_vgpr 256
  .amdhsa_next_free_sgpr 102
  .amdhsa_accum_offset 256
  .amdhsa_group_segment_fixed_size 0
  .amdhsa_kernarg_size 88
  .amdhsa_user_sgpr_count 2
  .amdhsa_user_sgpr_kernarg_segment_ptr 1
  .amdhsa_system_sgpr_workgroup_id_x 1
.end_amdhsa_kernel
```
